```python
import torch

def _softmax(x, axis=-1):
    return torch.softmax(x, dim=axis)
def _gelu(x):
    return torch.nn.functional.gelu(x, approximate="tanh")
def _silu(x):
    return torch.nn.functional.silu(x)
def _sigmoid(x):
    return torch.sigmoid(x)
def _layernorm(x, axis=-1, eps=1e-5):
    m = x.mean(dim=axis, keepdim=True)
    v = x.var(dim=axis, keepdim=True, unbiased=False)
    return (x - m) / torch.sqrt(v + eps)
def _scatter_add(tgt, idx, src, axis=0):
    return tgt.clone().index_add_(axis, idx, src)
def _segment_sum(src, seg, n):
    out = torch.zeros((n,) + src.shape[1:], dtype=src.dtype)
    return out.index_add_(0, seg, src)
def _pad(x, pw):
    flat = tuple(v for pair in reversed(pw) for v in pair)
    return torch.nn.functional.pad(x, flat)

kernel_name = 'parallel_sum__ssm_conv_h3__dense_activation_relu__prompt'

def setup_inputs():

    _w = (lambda a: (lambda t: t.to(torch.bfloat16) if t.is_floating_point() else t)(torch.as_tensor(a)))
    def _A_setup():
        B, S, D = 1, 2048, 512
        ks = 4
        return {
            "q": _w((lambda *s: torch.randn(*s, dtype=torch.bfloat16) * 0.05)(B, S, D)),
            "k": _w((lambda *s: torch.randn(*s, dtype=torch.bfloat16) * 0.4)(B, S, D)),
            "v": _w((lambda *s: torch.randn(*s, dtype=torch.bfloat16) * 0.4)(B, S, D)),
            "shift_k": _w((lambda *s: torch.randn(*s, dtype=torch.bfloat16) * 0.4)(D, ks) * 0.5),
            "ssm_k": _w((lambda *s: torch.randn(*s, dtype=torch.bfloat16) * 1.6)(D, S) * (1.0 / S ** 0.5)),
            "ssm_D": _w((lambda *s: torch.randn(*s, dtype=torch.bfloat16) * 0.4)(D)),
        }
    _A_in = _A_setup()

    def _B_setup():
        B, S, D, Dff = 1, 2048, 512, 1376
        return {
            "x": _w((lambda *s: torch.randn(*s, dtype=torch.bfloat16) * 0.05)(B, S, D)),
            "w1": _w((lambda *s: torch.randn(*s, dtype=torch.bfloat16) * 0.05)(D, Dff)),
            "w2": _w((lambda *s: torch.randn(*s, dtype=torch.bfloat16) * 0.05)(Dff, D)),
        }
    _B_in = _B_setup()

    return {
        "A_q": _A_in["q"],
        "A_k": _A_in["k"],
        "A_v": _A_in["v"],
        "A_shift_k": _A_in["shift_k"],
        "A_ssm_k": _A_in["ssm_k"],
        "A_ssm_D": _A_in["ssm_D"],
        "B_x": _B_in["x"],
        "B_w1": _B_in["w1"],
        "B_w2": _B_in["w2"],
    }

def reference(A_q, A_k, A_v, A_shift_k, A_ssm_k, A_ssm_D, B_x, B_w1, B_w2):
    def _A_ref(q, k, v, shift_k, ssm_k, ssm_D):
        B, S, D = q.shape
        ks = shift_k.shape[-1]
        k_pad = _pad(k, ((0, 0), (ks - 1, 0), (0, 0)))
        k_shift = torch.zeros_like(k)
        for t in range(ks):
            k_shift = k_shift + k_pad[:, t:t + S, :] * shift_k[:, ks - 1 - t][None, None, :]
        kv = k_shift * v
        L = 2 * S
        kv_pad = _pad(kv, ((0, 0), (0, S), (0, 0)))
        kf_pad = _pad(ssm_k, ((0, 0), (0, S)))
        kv_f = (lambda x, axes=(-2,-1): torch.fft.rfft2(x.float(), dim=axes))(kv_pad[:, None, :, :], axes=(1, 2))
        kf_f = (lambda x, axes=(-2,-1): torch.fft.rfft2(x.float(), dim=axes))(kf_pad[:, None, :], axes=(1, 2))
        kf_f = (lambda x, *d: x.permute(*d))(kf_f, 1, 2, 0)
        y_f = kv_f * kf_f[None, :, :, :]
        y = (lambda x, s, axes=(-2,-1): torch.fft.irfft2(x, s=s, dim=axes).to(torch.bfloat16))(y_f, (1, L), axes=(1, 2))[:, 0, :S, :]
        y = y + kv * ssm_D[None, None, :]
        return q * y

    def _B_ref(x, w1, w2):
        h = torch.einsum("bsd,df->bsf", x, w1)
        zero = torch.zeros_like(h)
        h = torch.maximum(h, zero)
        return torch.einsum("bsf,fd->bsd", h, w2)

    x = A_q
    xn = _layernorm(x, axis=-1)
    return x + _A_ref(xn, A_k, A_v, A_shift_k, A_ssm_k, A_ssm_D) + _B_ref(xn, B_w1, B_w2)
```

```asm
; @launch grid=(256,1,1) block=(256,1,1) lds=156928
.amdgcn_target "amdgcn-amd-amdhsa--gfx950"
.text
.globl parallel_sum__ssm_conv_h3__dense_activation_relu__prompt_kernel
.p2align 8
.type parallel_sum__ssm_conv_h3__dense_activation_relu__prompt_kernel,@function
parallel_sum__ssm_conv_h3__dense_activation_relu__prompt_kernel:
 s_cmp_ge_u32 s2, 256
 s_cbranch_scc1 k_end
 v_lshrrev_b32 v1, 6, v0
 v_and_b32 v2, 63, v0
 s_load_dwordx2 s[44:45], s[0:1], 88
 s_load_dwordx2 s[4:5], s[0:1], 0
 s_load_dwordx2 s[8:9], s[0:1], 8
 s_load_dwordx2 s[12:13], s[0:1], 16
 s_load_dwordx2 s[16:17], s[0:1], 24
 s_load_dwordx2 s[20:21], s[0:1], 32
 s_load_dwordx2 s[24:25], s[0:1], 56
 s_load_dwordx2 s[28:29], s[0:1], 64
 s_load_dwordx2 s[32:33], s[0:1], 72
 s_load_dwordx2 s[46:47], s[0:1], 40
 s_load_dwordx2 s[48:49], s[0:1], 80
 v_readfirstlane_b32 s3, v1
 s_mov_b32 s40, 0xffff0000
 s_mov_b32 s41, 4096
 s_mov_b32 s42, 0x05040100
 s_mov_b32 s43, 0x07060302
 s_and_b32 s50, s2, 7
 s_lshr_b32 s51, s2, 3
 s_lshr_b32 s91, s50, 1
 s_lshl_b32 s52, s91, 2
 s_and_b32 s92, s51, 3
 s_add_u32 s52, s52, s92
 s_lshl_b32 s55, s91, 3
 s_and_b32 s92, s51, 7
 s_add_u32 s55, s55, s92
 s_and_b32 s91, s50, 1
 s_lshl_b32 s54, s91, 3
 s_lshr_b32 s92, s51, 2
 s_add_u32 s54, s54, s92
 s_mul_i32 s53, s54, 3
 s_min_u32 s53, s53, 40
 s_lshl_b32 s56, s91, 2
 s_lshr_b32 s92, s51, 3
 s_add_u32 s56, s56, s92
 s_lshr_b32 s57, s3, 1
 s_and_b32 s58, s3, 1
 s_lshl_b32 s63, s50, 5
 s_add_u32 s63, s63, s51
 s_lshl_b32 s59, s63, 13
 s_lshl_b32 s92, s3, 11
 s_add_u32 s59, s59, s92
 s_mul_i32 s60, s57, 12928
 s_add_u32 s60, s60, 98304
 s_lshl_b32 s61, s58, 11
 s_add_u32 s61, s61, s60
 s_lshl_b32 s62, s52, 4
 s_add_u32 s62, s62, s54
 v_lshlrev_b32 v3, 4, v2
 v_mov_b32 v31, 1
 v_and_b32 v13, 15, v2
 v_lshrrev_b32 v14, 4, v2
 s_lshl_b32 s63, s63, 2
 s_waitcnt lgkmcnt(0)
 s_load_dword s93, s[46:47], s63
 s_mov_b32 s6, 0x200000
 s_mov_b32 s7, 0x20000
 s_mov_b32 s10, 0x200000
 s_mov_b32 s11, 0x20000
 s_mov_b32 s14, 0x200000
 s_mov_b32 s15, 0x20000
 s_mov_b32 s18, 0x1000
 s_mov_b32 s19, 0x20000
 s_mov_b32 s22, 0x200000
 s_mov_b32 s23, 0x20000
 s_mov_b32 s26, 0x158000
 s_mov_b32 s27, 0x20000
 s_mov_b32 s30, 0x158000
 s_mov_b32 s31, 0x20000
 s_mov_b32 s34, 0x200000
 s_mov_b32 s35, 0x20000
 s_mov_b32 s36, s44
 s_mov_b32 s37, s45
 s_mov_b32 s38, 0x1000000
 s_mov_b32 s39, 0x20000
 s_or_b32 s91, s2, s3
 s_cmp_lg_u32 s91, 0
 s_cbranch_scc1 nz0
 v_add_u32 v4, 14680064, v3
 v_mov_b32 v8, 0
 v_mov_b32 v9, 0
 v_mov_b32 v10, 0
 v_mov_b32 v11, 0
 buffer_store_dwordx4 v[8:11], v4, s[36:39], 0 offen offset:0 sc1
 buffer_store_dwordx4 v[8:11], v4, s[36:39], 0 offen offset:1024 sc1
 buffer_store_dwordx4 v[8:11], v4, s[36:39], 0 offen offset:2048 sc1
 buffer_store_dwordx4 v[8:11], v4, s[36:39], 0 offen offset:3072 sc1
 buffer_store_dwordx4 v[8:11], v4, s[36:39], s41 offen offset:0 sc1
 buffer_store_dwordx4 v[8:11], v4, s[36:39], s41 offen offset:1024 sc1
 buffer_store_dwordx4 v[8:11], v4, s[36:39], s41 offen offset:2048 sc1
 buffer_store_dwordx4 v[8:11], v4, s[36:39], s41 offen offset:3072 sc1
nz0:
 s_lshl_b32 s91, s62, 13
 s_lshl_b32 s92, s3, 8
 s_add_u32 s91, s91, s92
 v_and_b32 v4, 7, v0
 v_lshrrev_b32 v5, 3, v2
 v_lshlrev_b32 v6, 10, v4
 v_lshl_add_u32 v6, v5, 4, v6
 v_add_u32 v6, s91, v6
 buffer_load_dwordx4 v[32:35], v6, s[4:7], 0 offen
 buffer_load_dwordx4 v[36:39], v6, s[4:7], 0 offen offset:128
 s_lshl_b32 s91, s51, 16
 s_lshl_b32 s92, s50, 7
 s_add_u32 s91, s91, s92
 v_and_b32 v7, 31, v0
 v_lshrrev_b32 v12, 5, v0
 s_lshl_b32 s92, s3, 14
 s_add_u32 s91, s91, s92
 v_lshlrev_b32 v15, 10, v5
 v_lshl_add_u32 v15, v4, 4, v15
 v_add_u32 v15, s91, v15
 v_subrev_u32 v16, 8192, v15
 s_mul_i32 s95, s3, 5120
 s_add_u32 s95, s95, 124160
 s_mov_b32 s94, 8192
 s_lshl_b32 s91, s50, 9
 v_lshlrev_b32 v17, 4, v7
 v_add_u32 v17, s91, v17
 buffer_load_dwordx4 v[40:43], v17, s[16:19], 0 offen
 s_add_u32 m0, s95, 0
 s_nop 0
 buffer_load_dwordx4 v16, s[8:11], 0 offen nt lds
 s_add_u32 m0, s95, 1024
 s_nop 0
 buffer_load_dwordx4 v15, s[8:11], 0 offen nt lds
 s_add_u32 m0, s95, 2048
 s_nop 0
 buffer_load_dwordx4 v15, s[8:11], s94 offen nt lds
 s_add_u32 m0, s95, 3072
 s_nop 0
 buffer_load_dwordx4 v15, s[12:15], 0 offen nt lds
 s_add_u32 m0, s95, 4096
 s_nop 0
 buffer_load_dwordx4 v15, s[12:15], s94 offen nt lds
 v_lshrrev_b32 v24, 5, v2
 v_lshlrev_b32 v24, 10, v24
 v_lshl_add_u32 v24, v7, 2, v24
 v_add_u32 v24, s95, v24
 v_add_u32 v25, 1024, v24
 v_add_u32 v26, 3072, v24
 s_min_u32 s91, s3, 2
 s_add_u32 s94, s53, s91
 s_mul_i32 s91, s52, 32*2752
 s_lshl_b32 s92, s94, 6
 s_add_u32 s91, s91, s92
 v_mul_u32_u24 v21, 8*2752, v14
 v_lshl_add_u32 v21, v13, 2, v21
 v_add_u32 v21, s91, v21
 s_cmp_eq_u32 s3, 3
 s_cselect_b64 s[96:97], 1, -1
 s_mov_b64 exec, s[96:97]
 s_mov_b32 s91, 0
 buffer_load_dword v104, v21, s[24:27], s91 offen nt
 s_mov_b32 s91, 2752
 buffer_load_dword v105, v21, s[24:27], s91 offen nt
 s_mov_b32 s91, 5504
 buffer_load_dword v106, v21, s[24:27], s91 offen nt
 s_mov_b32 s91, 8256
 buffer_load_dword v107, v21, s[24:27], s91 offen nt
 s_mov_b32 s91, 11008
 buffer_load_dword v108, v21, s[24:27], s91 offen nt
 s_mov_b32 s91, 13760
 buffer_load_dword v109, v21, s[24:27], s91 offen nt
 s_mov_b32 s91, 16512
 buffer_load_dword v110, v21, s[24:27], s91 offen nt
 s_mov_b32 s91, 19264
 buffer_load_dword v111, v21, s[24:27], s91 offen nt
 s_mov_b64 exec, -1
 v_add_u32 v18, s59, v3
 v_subrev_u32 v19, 4, v18
 v_add_u32 v20, 1020, v18
 buffer_load_dwordx4 v[64:67], v18, s[20:23], 0 offen nt
 buffer_load_dword v72, v19, s[20:23], 0 offen
 buffer_load_dwordx4 v[68:71], v18, s[20:23], 0 offen offset:1024 nt
 buffer_load_dword v73, v20, s[20:23], 0 offen
 s_lshl_b32 s91, s51, 2
 s_add_u32 s91, s91, s3
 s_and_b32 s94, s50, 1
 s_mul_i32 s92, s91, 11*1024
 s_lshl_b32 s95, s94, 9
 s_add_u32 s92, s92, s95
 v_min_u32 v19, 43, v2
 v_lshrrev_b32 v20, 2, v19
 v_and_b32 v19, 3, v19
 v_lshlrev_b32 v19, 7, v19
 v_lshl_add_u32 v19, v20, 10, v19
 buffer_load_dword v75, v19, s[28:31], s92 offen
 s_mul_i32 s91, s3, 11*32768
 s_lshl_b32 s92, s56, 7
 s_add_u32 s91, s91, s92
 s_lshl_b32 s63, s3, 12
 v_bfe_u32 v8, v2, 4, 1
 v_lshlrev_b32 v8, 1, v8
 v_and_b32 v8, 2, v8
 v_xor_b32 v8, v8, v4
 v_xor_b32 v9, 4, v8
 v_lshlrev_b32 v8, 4, v8
 v_lshlrev_b32 v9, 4, v9
 v_lshl_add_u32 v8, v5, 10, v8
 v_lshl_add_u32 v9, v5, 10, v9
 v_add_u32 v8, s91, v8
 v_add_u32 v9, s91, v9
 v_bfe_u32 v28, v2, 2, 2
 v_lshlrev_b32 v28, 7, v28
 v_lshl_add_u32 v28, v14, 10, v28
 v_and_b32 v29, 3, v2
 v_lshl_add_u32 v28, v29, 3, v28
 v_bfe_u32 v29, v2, 3, 2
 v_lshlrev_b32 v29, 5, v29
 v_and_b32 v29, 96, v29
 v_add3_u32 v28, v28, v29, s63
 s_or_b32 s91, s2, s3
 s_cmp_lg_u32 s91, 0
 s_cbranch_scc1 nz1
 s_waitcnt vmcnt(21)
 v_mov_b32 v19, 0
 global_store_dword v19, v31, s[48:49] sc1
nz1:
 s_lshr_b32 s91, s62, 1
 s_lshl_b32 s91, s91, 14
 s_and_b32 s92, s62, 1
 s_lshl_b32 s92, s92, 7
 s_add_u32 s91, s91, s92
 s_lshl_b32 s92, s3, 12
 s_add_u32 s91, s91, s92
 v_lshlrev_b32 v6, 8, v5
 v_lshl_add_u32 v6, v4, 4, v6
 v_add_u32 v6, s91, v6
 v_lshlrev_b32 v22, 5, v4
 v_add_u32 v22, 152832, v22
 s_lshl_b32 s92, s3, 3
 v_add_u32 v23, s92, v22
 v_sub_u32 v10, 7, v12
 v_xor_b32 v10, v10, v4
 v_lshlrev_b32 v10, 4, v10
 v_lshl_add_u32 v10, v7, 8, v10
 v_add_u32 v10, 144640, v10
 v_lshrrev_b32 v15, 3, v0
 v_bfe_u32 v11, v0, 4, 3
 v_xor_b32 v11, v11, v4
 v_lshlrev_b32 v11, 4, v11
 v_lshl_add_u32 v11, v15, 7, v11
 v_add_u32 v11, 144640, v11
 s_lshl_b32 s91, s50, 18
 s_sub_u32 s92, 31, s51
 s_lshl_b32 s92, s92, 7
 s_add_u32 s91, s91, s92
 s_add_u32 s91, s91, 2097152
 v_lshlrev_b32 v15, 12, v15
 v_lshl_add_u32 v15, v4, 4, v15
 v_add_u32 v15, s91, v15
 s_min_u32 s91, s3, 2
 s_add_u32 s91, s53, s91
 s_lshl_b32 s91, s91, 15
 s_lshl_b32 s92, s52, 11
 s_add_u32 s91, s91, s92
 s_add_u32 s91, s91, 4194304
 v_add_u32 v21, s91, v3
 s_waitcnt vmcnt(19)
 v_lshlrev_b32 v80, 16, v32
 v_and_b32 v81, s40, v32
 v_lshlrev_b32 v82, 16, v33
 v_and_b32 v83, s40, v33
 v_lshlrev_b32 v84, 16, v34
 v_and_b32 v85, s40, v34
 v_lshlrev_b32 v86, 16, v35
 v_and_b32 v87, s40, v35
 v_lshlrev_b32 v88, 16, v36
 v_and_b32 v89, s40, v36
 v_lshlrev_b32 v90, 16, v37
 v_and_b32 v91, s40, v37
 v_lshlrev_b32 v92, 16, v38
 v_and_b32 v93, s40, v38
 v_lshlrev_b32 v94, 16, v39
 v_and_b32 v95, s40, v39
 v_pk_add_f32 v[96:97], v[80:81], v[82:83]
 v_pk_add_f32 v[96:97], v[96:97], v[84:85]
 v_pk_add_f32 v[96:97], v[96:97], v[86:87]
 v_pk_add_f32 v[96:97], v[96:97], v[88:89]
 v_pk_add_f32 v[96:97], v[96:97], v[90:91]
 v_pk_add_f32 v[96:97], v[96:97], v[92:93]
 v_pk_add_f32 v[96:97], v[96:97], v[94:95]
 v_add_f32 v96, v96, v97
 s_nop 1
 v_add_f32_dpp v96, v96, v96 row_ror:8 row_mask:0xf bank_mask:0xf
 v_mov_b32 v97, v96
 s_nop 1
 v_permlane16_swap_b32 v96, v97
 v_add_f32 v96, v96, v97
 v_mov_b32 v97, v96
 s_nop 1
 v_permlane32_swap_b32 v96, v97
 v_add_f32 v96, v96, v97
 v_mul_f32 v96, 0x3c000000, v96
 v_mov_b32 v97, v96
 v_pk_add_f32 v[98:99], v[80:81], v[96:97] neg_lo:[0,1] neg_hi:[0,1]
 v_pk_mul_f32 v[100:101], v[98:99], v[98:99]
 v_pk_add_f32 v[98:99], v[82:83], v[96:97] neg_lo:[0,1] neg_hi:[0,1]
 v_pk_fma_f32 v[100:101], v[98:99], v[98:99], v[100:101]
 v_pk_add_f32 v[98:99], v[84:85], v[96:97] neg_lo:[0,1] neg_hi:[0,1]
 v_pk_fma_f32 v[100:101], v[98:99], v[98:99], v[100:101]
 v_pk_add_f32 v[98:99], v[86:87], v[96:97] neg_lo:[0,1] neg_hi:[0,1]
 v_pk_fma_f32 v[100:101], v[98:99], v[98:99], v[100:101]
 v_pk_add_f32 v[98:99], v[88:89], v[96:97] neg_lo:[0,1] neg_hi:[0,1]
 v_pk_fma_f32 v[100:101], v[98:99], v[98:99], v[100:101]
 v_pk_add_f32 v[98:99], v[90:91], v[96:97] neg_lo:[0,1] neg_hi:[0,1]
 v_pk_fma_f32 v[100:101], v[98:99], v[98:99], v[100:101]
 v_pk_add_f32 v[98:99], v[92:93], v[96:97] neg_lo:[0,1] neg_hi:[0,1]
 v_pk_fma_f32 v[100:101], v[98:99], v[98:99], v[100:101]
 v_pk_add_f32 v[98:99], v[94:95], v[96:97] neg_lo:[0,1] neg_hi:[0,1]
 v_pk_fma_f32 v[100:101], v[98:99], v[98:99], v[100:101]
 v_add_f32 v97, v100, v101
 s_nop 1
 v_add_f32_dpp v97, v97, v97 row_ror:8 row_mask:0xf bank_mask:0xf
 v_mov_b32 v98, v97
 s_nop 1
 v_permlane16_swap_b32 v97, v98
 v_add_f32 v97, v97, v98
 v_mov_b32 v98, v97
 s_nop 1
 v_permlane32_swap_b32 v97, v98
 v_add_f32 v97, v97, v98
 ds_write_b64 v23, v[96:97]
 s_waitcnt vmcnt(13)
 ds_read2_b32 v[44:45], v24 offset0:160 offset1:192
 ds_read_b32 v46, v24 offset:896
 ds_read2_b32 v[48:49], v25 offset0:0 offset1:32
 ds_read2_b32 v[50:51], v25 offset0:64 offset1:96
 ds_read2_b32 v[52:53], v25 offset0:128 offset1:160
 ds_read2_b32 v[54:55], v25 offset0:192 offset1:224
 ds_read2_b32 v[56:57], v26 offset0:0 offset1:32
 ds_read2_b32 v[58:59], v26 offset0:64 offset1:96
 ds_read2_b32 v[60:61], v26 offset0:128 offset1:160
 ds_read2_b32 v[62:63], v26 offset0:192 offset1:224
 v_lshlrev_b32 v112, 16, v40
 v_lshlrev_b32 v113, 16, v42
 v_and_b32 v114, s40, v40
 v_and_b32 v115, s40, v42
 v_lshlrev_b32 v116, 16, v41
 v_lshlrev_b32 v117, 16, v43
 v_and_b32 v118, s40, v41
 v_and_b32 v119, s40, v43
 s_waitcnt lgkmcnt(4)
 v_lshlrev_b32 v120, 16, v44
 v_and_b32 v121, s40, v44
 v_lshlrev_b32 v122, 16, v45
 v_and_b32 v123, s40, v45
 v_lshlrev_b32 v124, 16, v46
 v_and_b32 v125, s40, v46
 v_lshlrev_b32 v126, 16, v48
 v_and_b32 v127, s40, v48
 v_lshlrev_b32 v128, 16, v49
 v_and_b32 v129, s40, v49
 v_lshlrev_b32 v130, 16, v50
 v_and_b32 v131, s40, v50
 v_lshlrev_b32 v132, 16, v51
 v_and_b32 v133, s40, v51
 v_lshlrev_b32 v134, 16, v52
 v_and_b32 v135, s40, v52
 v_lshlrev_b32 v136, 16, v53
 v_and_b32 v137, s40, v53
 v_lshlrev_b32 v138, 16, v54
 v_and_b32 v139, s40, v54
 v_lshlrev_b32 v140, 16, v55
 v_and_b32 v141, s40, v55
 v_pk_mul_f32 v[142:143], v[120:121], v[118:119]
 v_pk_mul_f32 v[144:145], v[122:123], v[118:119]
 v_pk_mul_f32 v[146:147], v[124:125], v[118:119]
 v_pk_mul_f32 v[148:149], v[126:127], v[118:119]
 v_pk_mul_f32 v[150:151], v[128:129], v[118:119]
 v_pk_mul_f32 v[152:153], v[130:131], v[118:119]
 v_pk_mul_f32 v[154:155], v[132:133], v[118:119]
 v_pk_mul_f32 v[156:157], v[134:135], v[118:119]
 v_pk_fma_f32 v[142:143], v[122:123], v[116:117], v[142:143]
 v_pk_fma_f32 v[144:145], v[124:125], v[116:117], v[144:145]
 v_pk_fma_f32 v[146:147], v[126:127], v[116:117], v[146:147]
 v_pk_fma_f32 v[148:149], v[128:129], v[116:117], v[148:149]
 v_pk_fma_f32 v[150:151], v[130:131], v[116:117], v[150:151]
 v_pk_fma_f32 v[152:153], v[132:133], v[116:117], v[152:153]
 v_pk_fma_f32 v[154:155], v[134:135], v[116:117], v[154:155]
 v_pk_fma_f32 v[156:157], v[136:137], v[116:117], v[156:157]
 v_pk_fma_f32 v[142:143], v[124:125], v[114:115], v[142:143]
 v_pk_fma_f32 v[144:145], v[126:127], v[114:115], v[144:145]
 v_pk_fma_f32 v[146:147], v[128:129], v[114:115], v[146:147]
 v_pk_fma_f32 v[148:149], v[130:131], v[114:115], v[148:149]
 v_pk_fma_f32 v[150:151], v[132:133], v[114:115], v[150:151]
 v_pk_fma_f32 v[152:153], v[134:135], v[114:115], v[152:153]
 v_pk_fma_f32 v[154:155], v[136:137], v[114:115], v[154:155]
 v_pk_fma_f32 v[156:157], v[138:139], v[114:115], v[156:157]
 v_pk_fma_f32 v[142:143], v[126:127], v[112:113], v[142:143]
 v_pk_fma_f32 v[144:145], v[128:129], v[112:113], v[144:145]
 v_pk_fma_f32 v[146:147], v[130:131], v[112:113], v[146:147]
 v_pk_fma_f32 v[148:149], v[132:133], v[112:113], v[148:149]
 v_pk_fma_f32 v[150:151], v[134:135], v[112:113], v[150:151]
 v_pk_fma_f32 v[152:153], v[136:137], v[112:113], v[152:153]
 v_pk_fma_f32 v[154:155], v[138:139], v[112:113], v[154:155]
 v_pk_fma_f32 v[156:157], v[140:141], v[112:113], v[156:157]
 s_waitcnt lgkmcnt(0)
 v_lshlrev_b32 v120, 16, v56
 v_and_b32 v121, s40, v56
 v_lshlrev_b32 v122, 16, v57
 v_and_b32 v123, s40, v57
 v_lshlrev_b32 v124, 16, v58
 v_and_b32 v125, s40, v58
 v_lshlrev_b32 v126, 16, v59
 v_and_b32 v127, s40, v59
 v_lshlrev_b32 v128, 16, v60
 v_and_b32 v129, s40, v60
 v_lshlrev_b32 v130, 16, v61
 v_and_b32 v131, s40, v61
 v_lshlrev_b32 v132, 16, v62
 v_and_b32 v133, s40, v62
 v_lshlrev_b32 v134, 16, v63
 v_and_b32 v135, s40, v63
 v_pk_mul_f32 v[142:143], v[142:143], v[120:121]
 v_pk_mul_f32 v[144:145], v[144:145], v[122:123]
 v_pk_mul_f32 v[146:147], v[146:147], v[124:125]
 v_pk_mul_f32 v[148:149], v[148:149], v[126:127]
 v_pk_mul_f32 v[150:151], v[150:151], v[128:129]
 v_pk_mul_f32 v[152:153], v[152:153], v[130:131]
 v_pk_mul_f32 v[154:155], v[154:155], v[132:133]
 v_pk_mul_f32 v[156:157], v[156:157], v[134:135]
 v_cvt_pk_bf16_f32 v40, v156, v154
 v_cvt_pk_bf16_f32 v41, v152, v150
 v_cvt_pk_bf16_f32 v42, v148, v146
 v_cvt_pk_bf16_f32 v43, v144, v142
 v_cvt_pk_bf16_f32 v44, v157, v155
 v_cvt_pk_bf16_f32 v45, v153, v151
 v_cvt_pk_bf16_f32 v46, v149, v147
 v_cvt_pk_bf16_f32 v47, v145, v143
 ds_write_b128 v10, v[40:43]
 ds_write_b128 v10, v[44:47] offset:128
 s_waitcnt vmcnt(5)
 v_perm_b32 v56, v105, v104, s42
 v_perm_b32 v57, v107, v106, s42
 v_perm_b32 v58, v109, v108, s42
 v_perm_b32 v59, v111, v110, s42
 v_perm_b32 v60, v105, v104, s43
 v_perm_b32 v61, v107, v106, s43
 v_perm_b32 v62, v109, v108, s43
 v_perm_b32 v63, v111, v110, s43
 s_mov_b64 exec, s[96:97]
 buffer_store_dwordx4 v[56:59], v21, s[36:39], 0 offen sc1
 buffer_store_dwordx4 v[60:63], v21, s[36:39], 0 offen offset:1024 sc1
 s_mov_b64 exec, -1
 s_waitcnt lgkmcnt(0)
 s_barrier
 ds_read_b128 v[96:99], v22
 ds_read_b128 v[100:103], v22 offset:16
 ds_read_b128 v[48:51], v11
 ds_read_b128 v[52:55], v11 offset:4096
 s_mov_b32 s91, 0x20000
 s_waitcnt lgkmcnt(2)
 v_add_f32 v104, v96, v98
 v_add_f32 v105, v100, v102
 v_add_f32 v104, v104, v105
 v_mul_f32 v104, 0x3e800000, v104
 v_add_f32 v97, v97, v99
 v_add_f32 v101, v101, v103
 v_add_f32 v97, v97, v101
 v_sub_f32 v96, v96, v104
 v_sub_f32 v98, v98, v104
 v_sub_f32 v100, v100, v104
 v_sub_f32 v102, v102, v104
 v_mul_f32 v96, v96, v96
 v_fmac_f32 v96, v98, v98
 v_fmac_f32 v96, v100, v100
 v_fmac_f32 v96, v102, v102
 v_fmac_f32 v97, 0x43000000, v96
 v_mul_f32 v105, 0x3b000000, v97
 s_waitcnt lgkmcnt(0)
 buffer_store_dwordx4 v[48:51], v15, s[36:39], 0 offen sc1
 buffer_store_dwordx4 v[52:55], v15, s[36:39], s91 offen sc1
 v_cvt_pk_bf16_f32 v106, v104, v105
 v_lshlrev_b32 v104, 16, v106
 v_and_b32 v105, s40, v106
 v_add_f32 v105, 0x3727c5ac, v105
 v_cvt_pk_bf16_f32 v106, v105, v107
 v_lshlrev_b32 v105, 16, v106
 v_and_b32 v107, s40, v106
 v_sqrt_f32 v105, v105
 s_nop 0
 v_cvt_pk_bf16_f32 v106, v105, v107
 v_lshlrev_b32 v105, 16, v106
 v_and_b32 v107, s40, v106
 v_rcp_f32 v106, v105
 v_mov_b32 v105, v104
 v_mov_b32 v107, v106
 v_pk_add_f32 v[80:81], v[80:81], v[104:105] neg_lo:[0,1] neg_hi:[0,1]
 v_cvt_pk_bf16_f32 v96, v80, v81
 v_lshlrev_b32 v80, 16, v96
 v_and_b32 v81, s40, v96
 v_pk_mul_f32 v[80:81], v[80:81], v[106:107]
 v_cvt_pk_bf16_f32 v32, v80, v81
 v_pk_add_f32 v[82:83], v[82:83], v[104:105] neg_lo:[0,1] neg_hi:[0,1]
 v_cvt_pk_bf16_f32 v96, v82, v83
 v_lshlrev_b32 v82, 16, v96
 v_and_b32 v83, s40, v96
 v_pk_mul_f32 v[82:83], v[82:83], v[106:107]
 v_cvt_pk_bf16_f32 v33, v82, v83
 v_pk_add_f32 v[84:85], v[84:85], v[104:105] neg_lo:[0,1] neg_hi:[0,1]
 v_cvt_pk_bf16_f32 v96, v84, v85
 v_lshlrev_b32 v84, 16, v96
 v_and_b32 v85, s40, v96
 v_pk_mul_f32 v[84:85], v[84:85], v[106:107]
 v_cvt_pk_bf16_f32 v34, v84, v85
 v_pk_add_f32 v[86:87], v[86:87], v[104:105] neg_lo:[0,1] neg_hi:[0,1]
 v_cvt_pk_bf16_f32 v96, v86, v87
 v_lshlrev_b32 v86, 16, v96
 v_and_b32 v87, s40, v96
 v_pk_mul_f32 v[86:87], v[86:87], v[106:107]
 v_cvt_pk_bf16_f32 v35, v86, v87
 v_pk_add_f32 v[88:89], v[88:89], v[104:105] neg_lo:[0,1] neg_hi:[0,1]
 v_cvt_pk_bf16_f32 v96, v88, v89
 v_lshlrev_b32 v88, 16, v96
 v_and_b32 v89, s40, v96
 v_pk_mul_f32 v[88:89], v[88:89], v[106:107]
 v_cvt_pk_bf16_f32 v36, v88, v89
 v_pk_add_f32 v[90:91], v[90:91], v[104:105] neg_lo:[0,1] neg_hi:[0,1]
 v_cvt_pk_bf16_f32 v96, v90, v91
 v_lshlrev_b32 v90, 16, v96
 v_and_b32 v91, s40, v96
 v_pk_mul_f32 v[90:91], v[90:91], v[106:107]
 v_cvt_pk_bf16_f32 v37, v90, v91
 v_pk_add_f32 v[92:93], v[92:93], v[104:105] neg_lo:[0,1] neg_hi:[0,1]
 v_cvt_pk_bf16_f32 v96, v92, v93
 v_lshlrev_b32 v92, 16, v96
 v_and_b32 v93, s40, v96
 v_pk_mul_f32 v[92:93], v[92:93], v[106:107]
 v_cvt_pk_bf16_f32 v38, v92, v93
 v_pk_add_f32 v[94:95], v[94:95], v[104:105] neg_lo:[0,1] neg_hi:[0,1]
 v_cvt_pk_bf16_f32 v96, v94, v95
 v_lshlrev_b32 v94, 16, v96
 v_and_b32 v95, s40, v96
 v_pk_mul_f32 v[94:95], v[94:95], v[106:107]
 v_cvt_pk_bf16_f32 v39, v94, v95
 buffer_store_dwordx4 v[32:35], v6, s[36:39], 0 offen sc1
 buffer_store_dwordx4 v[36:39], v6, s[36:39], 0 offen offset:2048 sc1
 v_mov_b32 v1, 0
 global_load_dword v1, v1, s[48:49] sc1
 s_add_u32 m0, s63, 0
 s_mov_b32 s91, 0
 buffer_load_dwordx4 v8, s[28:31], s91 offen lds
 s_add_u32 m0, s63, 1024
 s_mov_b32 s91, 8192
 buffer_load_dwordx4 v9, s[28:31], s91 offen lds
 s_add_u32 m0, s63, 2048
 s_mov_b32 s91, 16384
 buffer_load_dwordx4 v8, s[28:31], s91 offen lds
 s_add_u32 m0, s63, 3072
 s_mov_b32 s91, 24576
 buffer_load_dwordx4 v9, s[28:31], s91 offen lds
 s_add_u32 m0, s63, 16384
 s_mov_b32 s91, 32768
 buffer_load_dwordx4 v8, s[28:31], s91 offen lds
 s_add_u32 m0, s63, 17408
 s_mov_b32 s91, 40960
 buffer_load_dwordx4 v9, s[28:31], s91 offen lds
 s_add_u32 m0, s63, 18432
 s_mov_b32 s91, 49152
 buffer_load_dwordx4 v8, s[28:31], s91 offen lds
 s_add_u32 m0, s63, 19456
 s_mov_b32 s91, 57344
 buffer_load_dwordx4 v9, s[28:31], s91 offen lds
 s_add_u32 m0, s63, 32768
 s_mov_b32 s91, 65536
 buffer_load_dwordx4 v8, s[28:31], s91 offen lds
 s_add_u32 m0, s63, 33792
 s_mov_b32 s91, 73728
 buffer_load_dwordx4 v9, s[28:31], s91 offen lds
 s_add_u32 m0, s63, 34816
 s_mov_b32 s91, 81920
 buffer_load_dwordx4 v8, s[28:31], s91 offen lds
 s_add_u32 m0, s63, 35840
 s_mov_b32 s91, 90112
 buffer_load_dwordx4 v9, s[28:31], s91 offen lds
 s_lshl_b32 s91, s52, 7
 s_lshl_b32 s92, s54, 2
 s_add_u32 s96, s91, s92
 s_add_u32 s96, s96, 14680064
 s_lshl_b32 s92, s50, 7
 s_lshl_b32 s94, s51, 2
 s_add_u32 s97, s92, s94
 s_add_u32 s97, s97, 14682112
 v_mov_b32 v11, s96
 v_mov_b32 v15, s97
 v_cmp_eq_u32 vcc, 0, v2
 s_add_u32 s91, s91, 14680064
 s_add_u32 s92, s92, 14682112
 v_cndmask_b32 v11, v15, v11, vcc
 v_lshlrev_b32 v15, 2, v13
 v_add_u32 v15, s91, v15
 v_lshlrev_b32 v20, 2, v2
 v_cmp_gt_u32 vcc, 32, v2
 v_add_u32 v20, s92, v20
 v_cndmask_b32 v20, v15, v20, vcc
 s_lshl_b32 s91, s54, 7
 s_add_u32 s91, s91, 14686208
 s_lshl_b32 s92, s52, 2
 s_add_u32 s92, s92, s91
 v_lshlrev_b32 v15, 2, v13
 v_cmp_le_u32 vcc, 48, v2
 v_add_u32 v15, s91, v15
 v_mov_b32 v21, s92
 v_cndmask_b32 v20, v20, v15, vcc
 v_cmp_eq_u32 vcc, 2, v2
 s_nop 1
 v_cndmask_b32 v11, v11, v21, vcc
 s_waitcnt vmcnt(12) lgkmcnt(0)
 v_cmp_ne_u32 vcc, 1, v1
 s_cbranch_vccz go_ok
 v_mov_b32 v15, 0
 s_mov_b32 s92, 0
poll0:
 global_load_dword v30, v15, s[48:49] sc1
 s_add_u32 s92, s92, 1
 s_cmp_ge_u32 s92, 0x40000
 s_cbranch_scc1 pollx0
 s_waitcnt vmcnt(0)
 v_cmp_ne_u32 vcc, 1, v30
 s_cbranch_vccz pollx0
 s_sleep 1
 s_branch poll0
pollx0:
go_ok:
 s_barrier
 s_cmp_lg_u32 s3, 0
 s_cbranch_scc1 sig0
 s_mov_b64 exec, 7
 buffer_store_dword v31, v11, s[36:39], 0 offen sc1
 s_mov_b64 exec, -1
sig0:
 s_add_u32 m0, s63, 49152
 s_mov_b32 s91, 98304
 buffer_load_dwordx4 v8, s[28:31], s91 offen lds
 s_add_u32 m0, s63, 50176
 s_mov_b32 s91, 106496
 buffer_load_dwordx4 v9, s[28:31], s91 offen lds
 s_add_u32 m0, s63, 51200
 s_mov_b32 s91, 114688
 buffer_load_dwordx4 v8, s[28:31], s91 offen lds
 s_add_u32 m0, s63, 52224
 s_mov_b32 s91, 122880
 buffer_load_dwordx4 v9, s[28:31], s91 offen lds
 s_add_u32 m0, s63, 65536
 s_mov_b32 s91, 131072
 buffer_load_dwordx4 v8, s[28:31], s91 offen lds
 s_add_u32 m0, s63, 66560
 s_mov_b32 s91, 139264
 buffer_load_dwordx4 v9, s[28:31], s91 offen lds
 s_add_u32 m0, s63, 67584
 s_mov_b32 s91, 147456
 buffer_load_dwordx4 v8, s[28:31], s91 offen lds
 s_add_u32 m0, s63, 68608
 s_mov_b32 s91, 155648
 buffer_load_dwordx4 v9, s[28:31], s91 offen lds
 s_add_u32 m0, s63, 81920
 s_mov_b32 s91, 163840
 buffer_load_dwordx4 v8, s[28:31], s91 offen lds
 s_add_u32 m0, s63, 82944
 s_mov_b32 s91, 172032
 buffer_load_dwordx4 v9, s[28:31], s91 offen lds
 s_add_u32 m0, s63, 83968
 s_mov_b32 s91, 180224
 buffer_load_dwordx4 v8, s[28:31], s91 offen lds
 s_add_u32 m0, s63, 84992
 s_mov_b32 s91, 188416
 buffer_load_dwordx4 v9, s[28:31], s91 offen lds
 s_add_u32 m0, s63, 124160
 s_mov_b32 s91, 294912
 buffer_load_dwordx4 v8, s[28:31], s91 offen lds
 s_add_u32 m0, s63, 125184
 s_mov_b32 s91, 303104
 buffer_load_dwordx4 v9, s[28:31], s91 offen lds
 s_add_u32 m0, s63, 126208
 s_mov_b32 s91, 311296
 buffer_load_dwordx4 v8, s[28:31], s91 offen lds
 s_add_u32 m0, s63, 127232
 s_mov_b32 s91, 319488
 buffer_load_dwordx4 v9, s[28:31], s91 offen lds
 s_add_u32 m0, s63, 140544
 s_mov_b32 s91, 327680
 buffer_load_dwordx4 v8, s[28:31], s91 offen lds
 s_add_u32 m0, s63, 141568
 s_mov_b32 s91, 335872
 buffer_load_dwordx4 v9, s[28:31], s91 offen lds
 s_add_u32 m0, s63, 142592
 s_mov_b32 s91, 344064
 buffer_load_dwordx4 v8, s[28:31], s91 offen lds
 s_add_u32 m0, s63, 143616
 s_mov_b32 s91, 352256
 buffer_load_dwordx4 v9, s[28:31], s91 offen lds
 s_waitcnt vmcnt(40)
 v_mov_b32 v76, 0
 v_mov_b32 v77, 0
 v_mov_b32 v78, 0
 v_mov_b32 v79, 0
 v_min_u32 v10, 29, v2
 v_lshlrev_b32 v10, 4, v10
 v_add_u32 v10, s60, v10
 v_bfe_u32 v29, v2, 1, 1
 v_mul_u32_u24 v29, 4160, v29
 v_and_b32 v12, 1, v2
 v_lshl_add_u32 v29, v12, 4, v29
 v_add_u32 v29, s60, v29
 v_or_b32 v0, s58, v2
 v_cmp_ne_u32 vcc, 0, v0
 ds_write_b128 v10, v[76:79] offset:12416
 ds_write_b128 v29, v[76:79]
 v_add_u32 v10, s61, v3
 v_cndmask_b32 v72, 0, v72, vcc
 ds_write_b128 v10, v[64:67] offset:32
 ds_write_b128 v10, v[68:71] offset:1056
 v_alignbyte_b32 v80, v64, v72, 2
 v_alignbyte_b32 v81, v65, v64, 2
 v_alignbyte_b32 v82, v66, v65, 2
 v_alignbyte_b32 v83, v67, v66, 2
 ds_write_b128 v10, v[80:83] offset:4192
 v_alignbyte_b32 v84, v68, v73, 2
 v_alignbyte_b32 v85, v69, v68, 2
 v_alignbyte_b32 v86, v70, v69, 2
 v_alignbyte_b32 v87, v71, v70, 2
 ds_write_b128 v10, v[84:87] offset:5216
 v_xor_b32 v12, 1, v12
 v_mul_u32_u24 v12, 4160, v12
 v_or_b32 v15, 1, v13
 v_lshl_add_u32 v12, v15, 1, v12
 v_lshl_add_u32 v12, v14, 4, v12
 s_lshl_b32 s94, s58, 8
 s_add_u32 s94, s94, s60
 s_add_u32 s91, s94, 2
 v_add_u32 v16, s91, v12
 v_add_u32 v17, 1024, v16
 v_add_u32 v18, 2048, v16
 v_add_u32 v19, 3072, v16
 v_lshlrev_b32 v15, 5, v13
 v_lshlrev_b32 v21, 4, v14
 v_sub_u32 v21, v21, v15
 s_add_u32 s91, s94, 8800
 v_add_u32 v21, s91, v21
 v_lshl_add_u32 v22, v14, 3, v15
 s_lshl_b32 s91, s58, 11
 s_sub_u32 s91, s60, s91
 s_add_u32 s91, s91, 10872
 v_sub_u32 v23, s91, v22
 s_add_u32 s91, s59, 6291456
 v_add_u32 v22, s91, v22
 s_lshl_b32 s91, s3, 12
 s_add_u32 s92, s91, 0
 v_add_u32 v24, s92, v3
 s_xor_b32 s91, s91, 4096
 s_add_u32 s92, s91, 0
 v_add_u32 v25, s92, v3
 v_add_u32 v26, 0x10000, v3
 s_lshl_b32 s91, s53, 15
 s_add_u32 s91, s91, 4194304
 v_add_u32 v27, s91, v3
 s_lshl_b32 s95, s3, 11
 s_lshl_b32 s94, s52, 2
 s_add_u32 s94, s94, s3
 s_lshl_b32 s91, s94, 15
 v_add_u32 v4, s91, v3
 v_add_u32 v5, 0x4000, v4
 s_mul_i32 s91, s94, 86
 s_add_u32 s91, s91, s53
 s_lshl_b32 s91, s91, 10
 s_add_u32 s91, s91, 8388608
 v_add_u32 v6, s91, v3
 v_add_u32 v7, 43*1024, v6
 s_add_u32 s91, s59, 2097152
 v_add_u32 v10, s91, v3
 s_lshl_b32 s91, s57, 4
 s_lshr_b32 s93, s93, s91
 s_lshl_b32 s93, s93, 16
 s_waitcnt vmcnt(8)
 v_xor_b32 v0, 0, v28
 ds_read_b64_tr_b16 v[112:113], v0 offset:0
 ds_read_b64_tr_b16 v[114:115], v0 offset:512
 v_xor_b32 v0, 32, v28
 ds_read_b64_tr_b16 v[116:117], v0 offset:0
 ds_read_b64_tr_b16 v[118:119], v0 offset:512
 v_xor_b32 v0, 64, v28
 ds_read_b64_tr_b16 v[120:121], v0 offset:0
 ds_read_b64_tr_b16 v[122:123], v0 offset:512
 v_xor_b32 v0, 96, v28
 ds_read_b64_tr_b16 v[124:125], v0 offset:0
 ds_read_b64_tr_b16 v[126:127], v0 offset:512
 v_xor_b32 v0, 0, v28
 ds_read_b64_tr_b16 v[128:129], v0 offset:16384
 ds_read_b64_tr_b16 v[130:131], v0 offset:16896
 v_xor_b32 v0, 32, v28
 ds_read_b64_tr_b16 v[132:133], v0 offset:16384
 ds_read_b64_tr_b16 v[134:135], v0 offset:16896
 v_xor_b32 v0, 64, v28
 ds_read_b64_tr_b16 v[136:137], v0 offset:16384
 ds_read_b64_tr_b16 v[138:139], v0 offset:16896
 v_xor_b32 v0, 96, v28
 ds_read_b64_tr_b16 v[140:141], v0 offset:16384
 ds_read_b64_tr_b16 v[142:143], v0 offset:16896
 v_xor_b32 v0, 0, v28
 ds_read_b64_tr_b16 v[144:145], v0 offset:32768
 ds_read_b64_tr_b16 v[146:147], v0 offset:33280
 v_xor_b32 v0, 32, v28
 ds_read_b64_tr_b16 v[148:149], v0 offset:32768
 ds_read_b64_tr_b16 v[150:151], v0 offset:33280
 v_xor_b32 v0, 64, v28
 ds_read_b64_tr_b16 v[152:153], v0 offset:32768
 ds_read_b64_tr_b16 v[154:155], v0 offset:33280
 v_xor_b32 v0, 96, v28
 ds_read_b64_tr_b16 v[156:157], v0 offset:32768
 ds_read_b64_tr_b16 v[158:159], v0 offset:33280
 v_xor_b32 v0, 0, v28
 ds_read_b64_tr_b16 v[160:161], v0 offset:49152
 ds_read_b64_tr_b16 v[162:163], v0 offset:49664
 v_xor_b32 v0, 32, v28
 ds_read_b64_tr_b16 v[164:165], v0 offset:49152
 ds_read_b64_tr_b16 v[166:167], v0 offset:49664
 v_xor_b32 v0, 64, v28
 ds_read_b64_tr_b16 v[168:169], v0 offset:49152
 ds_read_b64_tr_b16 v[170:171], v0 offset:49664
 v_xor_b32 v0, 96, v28
 ds_read_b64_tr_b16 v[172:173], v0 offset:49152
 ds_read_b64_tr_b16 v[174:175], v0 offset:49664
 v_add_u32 v30, 65536, v28
 v_xor_b32 v0, 0, v30
 ds_read_b64_tr_b16 v[176:177], v0 offset:0
 ds_read_b64_tr_b16 v[178:179], v0 offset:512
 v_xor_b32 v0, 32, v30
 ds_read_b64_tr_b16 v[180:181], v0 offset:0
 ds_read_b64_tr_b16 v[182:183], v0 offset:512
 v_xor_b32 v0, 64, v30
 ds_read_b64_tr_b16 v[184:185], v0 offset:0
 ds_read_b64_tr_b16 v[186:187], v0 offset:512
 v_xor_b32 v0, 96, v30
 ds_read_b64_tr_b16 v[188:189], v0 offset:0
 ds_read_b64_tr_b16 v[190:191], v0 offset:512
 v_add_u32 v30, 81920, v28
 v_xor_b32 v0, 0, v30
 ds_read_b64_tr_b16 v[192:193], v0 offset:0
 ds_read_b64_tr_b16 v[194:195], v0 offset:512
 v_xor_b32 v0, 32, v30
 ds_read_b64_tr_b16 v[196:197], v0 offset:0
 ds_read_b64_tr_b16 v[198:199], v0 offset:512
 v_xor_b32 v0, 64, v30
 ds_read_b64_tr_b16 v[200:201], v0 offset:0
 ds_read_b64_tr_b16 v[202:203], v0 offset:512
 v_xor_b32 v0, 96, v30
 ds_read_b64_tr_b16 v[204:205], v0 offset:0
 ds_read_b64_tr_b16 v[206:207], v0 offset:512
 s_waitcnt lgkmcnt(0)
 s_barrier
 s_mov_b32 s92, 0
poll1:
 buffer_load_dword v30, v20, s[36:39], 0 offen sc1
 s_add_u32 s92, s92, 1
 s_cmp_ge_u32 s92, 0x40000
 s_cbranch_scc1 pollx1
 s_waitcnt vmcnt(0)
 v_cmp_ne_u32 vcc, 1, v30
 s_cbranch_vccz pollx1
 s_sleep 1
 s_branch poll1
pollx1:
 s_add_u32 m0, s61, 8320
 s_nop 0
 buffer_load_dwordx4 v10, s[36:39], 0 offen sc1 lds
 buffer_load_dwordx4 v10, s[36:39], 0 offen offset:1024 sc1 lds
 s_add_u32 m0, s95, 0
 s_mov_b32 s94, 0
 buffer_load_dwordx4 v27, s[36:39], m0 offen sc1 lds
 buffer_load_dwordx4 v27, s[36:39], m0 offen offset:1024 sc1 lds
 buffer_load_dwordx4 a[0:3], v4, s[36:39], s94 offen offset:0 sc1
 buffer_load_dwordx4 a[4:7], v5, s[36:39], s94 offen offset:0 sc1
 buffer_load_dwordx4 a[8:11], v4, s[36:39], s94 offen offset:1024 sc1
 buffer_load_dwordx4 a[12:15], v5, s[36:39], s94 offen offset:1024 sc1
 buffer_load_dwordx4 a[16:19], v4, s[36:39], s94 offen offset:2048 sc1
 buffer_load_dwordx4 a[20:23], v5, s[36:39], s94 offen offset:2048 sc1
 buffer_load_dwordx4 a[24:27], v4, s[36:39], s94 offen offset:3072 sc1
 buffer_load_dwordx4 a[28:31], v5, s[36:39], s94 offen offset:3072 sc1
 s_waitcnt vmcnt(10) lgkmcnt(0)
 s_barrier
 ds_read2_b32 a[128:129], v16 offset0:0 offset1:1
 ds_read2_b32 a[130:131], v16 offset0:2 offset1:3
 ds_read_b128 a[160:163], v21 offset:3584
 ds_read_b128 a[164:167], v21 offset:3072
 ds_read_b128 a[168:171], v21 offset:2560
 ds_read_b128 a[172:175], v21 offset:2048
 ds_read_b128 a[176:179], v21 offset:1536
 ds_read_b128 a[180:183], v21 offset:1024
 ds_read_b128 a[184:187], v21 offset:512
 ds_read_b128 a[188:191], v21 offset:0
 ds_read2_b32 a[132:133], v16 offset0:128 offset1:129
 ds_read2_b32 a[134:135], v16 offset0:130 offset1:131
 ds_read2_b32 a[136:137], v17 offset0:0 offset1:1
 ds_read2_b32 a[138:139], v17 offset0:2 offset1:3
 ds_read2_b32 a[140:141], v17 offset0:128 offset1:129
 ds_read2_b32 a[142:143], v17 offset0:130 offset1:131
 ds_read2_b32 a[144:145], v18 offset0:0 offset1:1
 ds_read2_b32 a[146:147], v18 offset0:2 offset1:3
 ds_read2_b32 a[148:149], v18 offset0:128 offset1:129
 ds_read2_b32 a[150:151], v18 offset0:130 offset1:131
 ds_read2_b32 a[152:153], v19 offset0:0 offset1:1
 ds_read2_b32 a[154:155], v19 offset0:2 offset1:3
 ds_read2_b32 a[156:157], v19 offset0:128 offset1:129
 ds_read2_b32 a[158:159], v19 offset0:130 offset1:131
 s_waitcnt lgkmcnt(14)
 v_mfma_f32_16x16x32_bf16 v[32:35], a[128:131], a[160:163], 0
 v_mfma_f32_16x16x32_bf16 v[36:39], a[128:131], a[164:167], 0
 s_add_u32 m0, s95, 8192
 s_mov_b32 s94, 4096
 buffer_load_dwordx4 v27, s[36:39], m0 offen sc1 lds
 v_mfma_f32_16x16x32_bf16 v[40:43], a[128:131], a[168:171], 0
 v_mfma_f32_16x16x32_bf16 v[44:47], a[128:131], a[172:175], 0
 buffer_load_dwordx4 v27, s[36:39], m0 offen offset:1024 sc1 lds
 v_mfma_f32_16x16x32_bf16 v[48:51], a[128:131], a[176:179], 0
 v_mfma_f32_16x16x32_bf16 v[52:55], a[128:131], a[180:183], 0
 buffer_load_dwordx4 a[32:35], v4, s[36:39], s94 offen offset:0 sc1
 v_mfma_f32_16x16x32_bf16 v[56:59], a[128:131], a[184:187], 0
 v_mfma_f32_16x16x32_bf16 v[60:63], a[128:131], a[188:191], 0
 buffer_load_dwordx4 a[36:39], v5, s[36:39], s94 offen offset:0 sc1
 s_waitcnt lgkmcnt(12)
 v_mfma_f32_16x16x32_bf16 v[36:39], a[132:135], a[160:163], v[36:39]
 v_mfma_f32_16x16x32_bf16 v[40:43], a[132:135], a[164:167], v[40:43]
 buffer_load_dwordx4 a[40:43], v4, s[36:39], s94 offen offset:1024 sc1
 v_mfma_f32_16x16x32_bf16 v[44:47], a[132:135], a[168:171], v[44:47]
 v_mfma_f32_16x16x32_bf16 v[48:51], a[132:135], a[172:175], v[48:51]
 buffer_load_dwordx4 a[44:47], v5, s[36:39], s94 offen offset:1024 sc1
 v_mfma_f32_16x16x32_bf16 v[52:55], a[132:135], a[176:179], v[52:55]
 v_mfma_f32_16x16x32_bf16 v[56:59], a[132:135], a[180:183], v[56:59]
 buffer_load_dwordx4 a[48:51], v4, s[36:39], s94 offen offset:2048 sc1
 v_mfma_f32_16x16x32_bf16 v[60:63], a[132:135], a[184:187], v[60:63]
 s_waitcnt lgkmcnt(0)
 v_mfma_f32_16x16x32_bf16 v[40:43], a[136:139], a[160:163], v[40:43]
 ds_read2_b32 a[192:193], v16 offset0:16 offset1:17
 ds_read2_b32 a[194:195], v16 offset0:18 offset1:19
 buffer_load_dwordx4 a[52:55], v5, s[36:39], s94 offen offset:2048 sc1
 v_mfma_f32_16x16x32_bf16 v[44:47], a[136:139], a[164:167], v[44:47]
 ds_read_b128 a[224:227], v21 offset:3648
 ds_read_b128 a[228:231], v21 offset:3136
 v_mfma_f32_16x16x32_bf16 v[48:51], a[136:139], a[168:171], v[48:51]
 ds_read_b128 a[232:235], v21 offset:2624
 ds_read_b128 a[236:239], v21 offset:2112
 v_mfma_f32_16x16x32_bf16 v[52:55], a[136:139], a[172:175], v[52:55]
 ds_read_b128 a[240:243], v21 offset:1600
 ds_read_b128 a[244:247], v21 offset:1088
 v_mfma_f32_16x16x32_bf16 v[56:59], a[136:139], a[176:179], v[56:59]
 ds_read_b128 a[248:251], v21 offset:576
 ds_read_b128 a[252:255], v21 offset:64
 buffer_load_dwordx4 a[56:59], v4, s[36:39], s94 offen offset:3072 sc1
 v_mfma_f32_16x16x32_bf16 v[60:63], a[136:139], a[180:183], v[60:63]
 ds_read2_b32 a[196:197], v16 offset0:144 offset1:145
 ds_read2_b32 a[198:199], v16 offset0:146 offset1:147
 v_mfma_f32_16x16x32_bf16 v[44:47], a[140:143], a[160:163], v[44:47]
 ds_read2_b32 a[200:201], v17 offset0:16 offset1:17
 ds_read2_b32 a[202:203], v17 offset0:18 offset1:19
 v_mfma_f32_16x16x32_bf16 v[48:51], a[140:143], a[164:167], v[48:51]
 ds_read2_b32 a[204:205], v17 offset0:144 offset1:145
 ds_read2_b32 a[206:207], v17 offset0:146 offset1:147
 v_mfma_f32_16x16x32_bf16 v[52:55], a[140:143], a[168:171], v[52:55]
 ds_read2_b32 a[208:209], v18 offset0:16 offset1:17
 ds_read2_b32 a[210:211], v18 offset0:18 offset1:19
 buffer_load_dwordx4 a[60:63], v5, s[36:39], s94 offen offset:3072 sc1
 v_mfma_f32_16x16x32_bf16 v[56:59], a[140:143], a[172:175], v[56:59]
 ds_read2_b32 a[212:213], v18 offset0:144 offset1:145
 ds_read2_b32 a[214:215], v18 offset0:146 offset1:147
 v_mfma_f32_16x16x32_bf16 v[60:63], a[140:143], a[176:179], v[60:63]
 ds_read2_b32 a[216:217], v19 offset0:16 offset1:17
 ds_read2_b32 a[218:219], v19 offset0:18 offset1:19
 v_mfma_f32_16x16x32_bf16 v[48:51], a[144:147], a[160:163], v[48:51]
 ds_read2_b32 a[220:221], v19 offset0:144 offset1:145
 v_mfma_f32_16x16x32_bf16 v[52:55], a[144:147], a[164:167], v[52:55]
 ds_read2_b32 a[222:223], v19 offset0:146 offset1:147
 s_add_u32 m0, s95, 16384
 s_mov_b32 s94, 8192
 buffer_load_dwordx4 v27, s[36:39], m0 offen sc1 lds
 v_mfma_f32_16x16x32_bf16 v[56:59], a[144:147], a[168:171], v[56:59]
 v_mfma_f32_16x16x32_bf16 v[60:63], a[144:147], a[172:175], v[60:63]
 buffer_load_dwordx4 v27, s[36:39], m0 offen offset:1024 sc1 lds
 v_mfma_f32_16x16x32_bf16 v[52:55], a[148:151], a[160:163], v[52:55]
 v_mfma_f32_16x16x32_bf16 v[56:59], a[148:151], a[164:167], v[56:59]
 buffer_load_dwordx4 a[64:67], v4, s[36:39], s94 offen offset:0 sc1
 v_mfma_f32_16x16x32_bf16 v[60:63], a[148:151], a[168:171], v[60:63]
 v_mfma_f32_16x16x32_bf16 v[56:59], a[152:155], a[160:163], v[56:59]
 buffer_load_dwordx4 a[68:71], v5, s[36:39], s94 offen offset:0 sc1
 v_mfma_f32_16x16x32_bf16 v[60:63], a[152:155], a[164:167], v[60:63]
 v_mfma_f32_16x16x32_bf16 v[60:63], a[156:159], a[160:163], v[60:63]
 buffer_load_dwordx4 a[72:75], v4, s[36:39], s94 offen offset:1024 sc1
 s_waitcnt lgkmcnt(0)
 v_mfma_f32_16x16x32_bf16 v[32:35], a[192:195], a[224:227], v[32:35]
 ds_read2_b32 a[128:129], v16 offset0:32 offset1:33
 v_mfma_f32_16x16x32_bf16 v[36:39], a[192:195], a[228:231], v[36:39]
 ds_read2_b32 a[130:131], v16 offset0:34 offset1:35
 v_mfma_f32_16x16x32_bf16 v[40:43], a[192:195], a[232:235], v[40:43]
 ds_read_b128 a[160:163], v21 offset:3712
 v_mfma_f32_16x16x32_bf16 v[44:47], a[192:195], a[236:239], v[44:47]
 ds_read_b128 a[164:167], v21 offset:3200
 buffer_load_dwordx4 a[76:79], v5, s[36:39], s94 offen offset:1024 sc1
 v_mfma_f32_16x16x32_bf16 v[48:51], a[192:195], a[240:243], v[48:51]
 ds_read_b128 a[168:171], v21 offset:2688
 v_mfma_f32_16x16x32_bf16 v[52:55], a[192:195], a[244:247], v[52:55]
 ds_read_b128 a[172:175], v21 offset:2176
 v_mfma_f32_16x16x32_bf16 v[56:59], a[192:195], a[248:251], v[56:59]
 ds_read_b128 a[176:179], v21 offset:1664
 v_mfma_f32_16x16x32_bf16 v[60:63], a[192:195], a[252:255], v[60:63]
 ds_read_b128 a[180:183], v21 offset:1152
 buffer_load_dwordx4 a[80:83], v4, s[36:39], s94 offen offset:2048 sc1
 v_mfma_f32_16x16x32_bf16 v[36:39], a[196:199], a[224:227], v[36:39]
 ds_read_b128 a[184:187], v21 offset:640
 v_mfma_f32_16x16x32_bf16 v[40:43], a[196:199], a[228:231], v[40:43]
 ds_read_b128 a[188:191], v21 offset:128
 v_mfma_f32_16x16x32_bf16 v[44:47], a[196:199], a[232:235], v[44:47]
 ds_read2_b32 a[132:133], v16 offset0:160 offset1:161
 v_mfma_f32_16x16x32_bf16 v[48:51], a[196:199], a[236:239], v[48:51]
 ds_read2_b32 a[134:135], v16 offset0:162 offset1:163
 buffer_load_dwordx4 a[84:87], v5, s[36:39], s94 offen offset:2048 sc1
 v_mfma_f32_16x16x32_bf16 v[52:55], a[196:199], a[240:243], v[52:55]
 ds_read2_b32 a[136:137], v17 offset0:32 offset1:33
 v_mfma_f32_16x16x32_bf16 v[56:59], a[196:199], a[244:247], v[56:59]
 ds_read2_b32 a[138:139], v17 offset0:34 offset1:35
 v_mfma_f32_16x16x32_bf16 v[60:63], a[196:199], a[248:251], v[60:63]
 ds_read2_b32 a[140:141], v17 offset0:160 offset1:161
 v_mfma_f32_16x16x32_bf16 v[40:43], a[200:203], a[224:227], v[40:43]
 ds_read2_b32 a[142:143], v17 offset0:162 offset1:163
 buffer_load_dwordx4 a[88:91], v4, s[36:39], s94 offen offset:3072 sc1
 v_mfma_f32_16x16x32_bf16 v[44:47], a[200:203], a[228:231], v[44:47]
 ds_read2_b32 a[144:145], v18 offset0:32 offset1:33
 v_mfma_f32_16x16x32_bf16 v[48:51], a[200:203], a[232:235], v[48:51]
 ds_read2_b32 a[146:147], v18 offset0:34 offset1:35
 v_mfma_f32_16x16x32_bf16 v[52:55], a[200:203], a[236:239], v[52:55]
 ds_read2_b32 a[148:149], v18 offset0:160 offset1:161
 v_mfma_f32_16x16x32_bf16 v[56:59], a[200:203], a[240:243], v[56:59]
 ds_read2_b32 a[150:151], v18 offset0:162 offset1:163
 buffer_load_dwordx4 a[92:95], v5, s[36:39], s94 offen offset:3072 sc1
 v_mfma_f32_16x16x32_bf16 v[60:63], a[200:203], a[244:247], v[60:63]
 ds_read2_b32 a[152:153], v19 offset0:32 offset1:33
 v_mfma_f32_16x16x32_bf16 v[44:47], a[204:207], a[224:227], v[44:47]
 ds_read2_b32 a[154:155], v19 offset0:34 offset1:35
 v_mfma_f32_16x16x32_bf16 v[48:51], a[204:207], a[228:231], v[48:51]
 ds_read2_b32 a[156:157], v19 offset0:160 offset1:161
 v_mfma_f32_16x16x32_bf16 v[52:55], a[204:207], a[232:235], v[52:55]
 ds_read2_b32 a[158:159], v19 offset0:162 offset1:163
 s_add_u32 m0, s95, 24576
 s_mov_b32 s94, 12288
 buffer_load_dwordx4 v27, s[36:39], m0 offen sc1 lds
 v_mfma_f32_16x16x32_bf16 v[56:59], a[204:207], a[236:239], v[56:59]
 v_mfma_f32_16x16x32_bf16 v[60:63], a[204:207], a[240:243], v[60:63]
 buffer_load_dwordx4 v27, s[36:39], m0 offen offset:1024 sc1 lds
 v_mfma_f32_16x16x32_bf16 v[48:51], a[208:211], a[224:227], v[48:51]
 v_mfma_f32_16x16x32_bf16 v[52:55], a[208:211], a[228:231], v[52:55]
 buffer_load_dwordx4 a[96:99], v4, s[36:39], s94 offen offset:0 sc1
 v_mfma_f32_16x16x32_bf16 v[56:59], a[208:211], a[232:235], v[56:59]
 v_mfma_f32_16x16x32_bf16 v[60:63], a[208:211], a[236:239], v[60:63]
 buffer_load_dwordx4 a[100:103], v5, s[36:39], s94 offen offset:0 sc1
 v_mfma_f32_16x16x32_bf16 v[52:55], a[212:215], a[224:227], v[52:55]
 v_mfma_f32_16x16x32_bf16 v[56:59], a[212:215], a[228:231], v[56:59]
 buffer_load_dwordx4 a[104:107], v4, s[36:39], s94 offen offset:1024 sc1
 v_mfma_f32_16x16x32_bf16 v[60:63], a[212:215], a[232:235], v[60:63]
 v_mfma_f32_16x16x32_bf16 v[56:59], a[216:219], a[224:227], v[56:59]
 buffer_load_dwordx4 a[108:111], v5, s[36:39], s94 offen offset:1024 sc1
 v_mfma_f32_16x16x32_bf16 v[60:63], a[216:219], a[228:231], v[60:63]
 v_mfma_f32_16x16x32_bf16 v[60:63], a[220:223], a[224:227], v[60:63]
 s_waitcnt lgkmcnt(0)
 v_mfma_f32_16x16x32_bf16 v[32:35], a[128:131], a[160:163], v[32:35]
 v_mfma_f32_16x16x32_bf16 v[36:39], a[128:131], a[164:167], v[36:39]
 v_mfma_f32_16x16x32_bf16 v[40:43], a[128:131], a[168:171], v[40:43]
 v_mfma_f32_16x16x32_bf16 v[44:47], a[128:131], a[172:175], v[44:47]
 v_mfma_f32_16x16x32_bf16 v[48:51], a[128:131], a[176:179], v[48:51]
 v_mfma_f32_16x16x32_bf16 v[52:55], a[128:131], a[180:183], v[52:55]
 v_mfma_f32_16x16x32_bf16 v[56:59], a[128:131], a[184:187], v[56:59]
 v_mfma_f32_16x16x32_bf16 v[60:63], a[128:131], a[188:191], v[60:63]
 v_mfma_f32_16x16x32_bf16 v[36:39], a[132:135], a[160:163], v[36:39]
 v_mfma_f32_16x16x32_bf16 v[40:43], a[132:135], a[164:167], v[40:43]
 v_mfma_f32_16x16x32_bf16 v[44:47], a[132:135], a[168:171], v[44:47]
 v_mfma_f32_16x16x32_bf16 v[48:51], a[132:135], a[172:175], v[48:51]
 v_mfma_f32_16x16x32_bf16 v[52:55], a[132:135], a[176:179], v[52:55]
 v_mfma_f32_16x16x32_bf16 v[56:59], a[132:135], a[180:183], v[56:59]
 v_mfma_f32_16x16x32_bf16 v[60:63], a[132:135], a[184:187], v[60:63]
 v_mfma_f32_16x16x32_bf16 v[40:43], a[136:139], a[160:163], v[40:43]
 v_mfma_f32_16x16x32_bf16 v[44:47], a[136:139], a[164:167], v[44:47]
 v_mfma_f32_16x16x32_bf16 v[48:51], a[136:139], a[168:171], v[48:51]
 v_mfma_f32_16x16x32_bf16 v[52:55], a[136:139], a[172:175], v[52:55]
 v_mfma_f32_16x16x32_bf16 v[56:59], a[136:139], a[176:179], v[56:59]
 v_mfma_f32_16x16x32_bf16 v[60:63], a[136:139], a[180:183], v[60:63]
 v_mfma_f32_16x16x32_bf16 v[44:47], a[140:143], a[160:163], v[44:47]
 v_mfma_f32_16x16x32_bf16 v[48:51], a[140:143], a[164:167], v[48:51]
 v_mfma_f32_16x16x32_bf16 v[52:55], a[140:143], a[168:171], v[52:55]
 v_mfma_f32_16x16x32_bf16 v[56:59], a[140:143], a[172:175], v[56:59]
 v_mfma_f32_16x16x32_bf16 v[60:63], a[140:143], a[176:179], v[60:63]
 v_mfma_f32_16x16x32_bf16 v[48:51], a[144:147], a[160:163], v[48:51]
 v_mfma_f32_16x16x32_bf16 v[52:55], a[144:147], a[164:167], v[52:55]
 v_mfma_f32_16x16x32_bf16 v[56:59], a[144:147], a[168:171], v[56:59]
 v_mfma_f32_16x16x32_bf16 v[60:63], a[144:147], a[172:175], v[60:63]
 v_mfma_f32_16x16x32_bf16 v[52:55], a[148:151], a[160:163], v[52:55]
 v_mfma_f32_16x16x32_bf16 v[56:59], a[148:151], a[164:167], v[56:59]
 v_mfma_f32_16x16x32_bf16 v[60:63], a[148:151], a[168:171], v[60:63]
 v_mfma_f32_16x16x32_bf16 v[56:59], a[152:155], a[160:163], v[56:59]
 v_mfma_f32_16x16x32_bf16 v[60:63], a[152:155], a[164:167], v[60:63]
 v_mfma_f32_16x16x32_bf16 v[60:63], a[156:159], a[160:163], v[60:63]
 s_cmp_ge_u32 s54, 14
 s_cselect_b64 s[96:97], 1, -1
 s_cmp_ge_u32 s54, 15
 s_cselect_b64 s[98:99], 1, -1
 s_waitcnt vmcnt(26) lgkmcnt(0)
 s_barrier
 ds_read_b128 a[128:131], v3 offset:0
 ds_read_b128 a[132:135], v3 offset:1024
 ds_read_b128 a[136:139], v3 offset:2048
 ds_read_b128 a[140:143], v3 offset:3072
 ds_read_b128 a[144:147], v3 offset:4096
 ds_read_b128 a[148:151], v3 offset:5120
 s_waitcnt lgkmcnt(5)
 v_mfma_f32_16x16x32_bf16 a[176:179], a[128:131], a[0:3], 0
 v_mfma_f32_16x16x32_bf16 a[180:183], a[128:131], a[4:7], 0
 ds_read_b128 a[152:155], v3 offset:6144
 buffer_load_dwordx4 a[112:115], v4, s[36:39], s94 offen offset:2048 sc1
 s_waitcnt lgkmcnt(5)
 v_mfma_f32_16x16x32_bf16 a[184:187], a[132:135], a[0:3], 0
 v_mfma_f32_16x16x32_bf16 a[188:191], a[132:135], a[4:7], 0
 ds_read_b128 a[156:159], v3 offset:7168
 buffer_load_dwordx4 a[116:119], v5, s[36:39], s94 offen offset:2048 sc1
 s_waitcnt vmcnt(18)
 s_barrier
 s_waitcnt lgkmcnt(5)
 v_mfma_f32_16x16x32_bf16 a[176:179], a[136:139], a[8:11], a[176:179]
 v_mfma_f32_16x16x32_bf16 a[180:183], a[136:139], a[12:15], a[180:183]
 ds_read_b128 a[128:131], v3 offset:8192
 buffer_load_dwordx4 a[120:123], v4, s[36:39], s94 offen offset:3072 sc1
 s_waitcnt lgkmcnt(5)
 v_mfma_f32_16x16x32_bf16 a[184:187], a[140:143], a[8:11], a[184:187]
 v_mfma_f32_16x16x32_bf16 a[188:191], a[140:143], a[12:15], a[188:191]
 ds_read_b128 a[132:135], v3 offset:9216
 buffer_load_dwordx4 a[124:127], v5, s[36:39], s94 offen offset:3072 sc1
 s_waitcnt lgkmcnt(5)
 v_mfma_f32_16x16x32_bf16 a[176:179], a[144:147], a[16:19], a[176:179]
 v_mfma_f32_16x16x32_bf16 a[180:183], a[144:147], a[20:23], a[180:183]
 ds_read_b128 a[136:139], v3 offset:10240
 s_add_u32 m0, s95, 32768
 s_mov_b32 s94, 0
 buffer_load_dwordx4 v27, s[36:39], m0 offen sc1 lds
 s_waitcnt lgkmcnt(5)
 v_mfma_f32_16x16x32_bf16 a[184:187], a[148:151], a[16:19], a[184:187]
 v_mfma_f32_16x16x32_bf16 a[188:191], a[148:151], a[20:23], a[188:191]
 ds_read_b128 a[140:143], v3 offset:11264
 buffer_load_dwordx4 v27, s[36:39], m0 offen offset:1024 sc1 lds
 s_waitcnt lgkmcnt(5)
 v_mfma_f32_16x16x32_bf16 a[176:179], a[152:155], a[24:27], a[176:179]
 v_mfma_f32_16x16x32_bf16 a[180:183], a[152:155], a[28:31], a[180:183]
 ds_read_b128 a[144:147], v3 offset:12288
 s_add_u32 m0, s95, 40960
 s_mov_b32 s94, 4096
 buffer_load_dwordx4 v27, s[36:39], m0 offen sc1 lds
 s_waitcnt lgkmcnt(5)
 v_mfma_f32_16x16x32_bf16 a[184:187], a[156:159], a[24:27], a[184:187]
 v_mfma_f32_16x16x32_bf16 a[188:191], a[156:159], a[28:31], a[188:191]
 ds_read_b128 a[148:151], v3 offset:13312
 buffer_load_dwordx4 v27, s[36:39], m0 offen offset:1024 sc1 lds
 s_waitcnt lgkmcnt(5)
 v_mfma_f32_16x16x32_bf16 a[176:179], a[128:131], a[32:35], a[176:179]
 v_mfma_f32_16x16x32_bf16 a[180:183], a[128:131], a[36:39], a[180:183]
 ds_read_b128 a[152:155], v3 offset:14336
 s_add_u32 m0, s95, 49152
 s_mov_b32 s94, 8192
 buffer_load_dwordx4 v27, s[36:39], m0 offen sc1 lds
 s_waitcnt lgkmcnt(5)
 v_mfma_f32_16x16x32_bf16 a[184:187], a[132:135], a[32:35], a[184:187]
 v_mfma_f32_16x16x32_bf16 a[188:191], a[132:135], a[36:39], a[188:191]
 ds_read_b128 a[156:159], v3 offset:15360
 buffer_load_dwordx4 v27, s[36:39], m0 offen offset:1024 sc1 lds
 s_waitcnt vmcnt(16)
 s_barrier
 s_waitcnt lgkmcnt(5)
 v_mfma_f32_16x16x32_bf16 a[176:179], a[136:139], a[40:43], a[176:179]
 v_mfma_f32_16x16x32_bf16 a[180:183], a[136:139], a[44:47], a[180:183]
 ds_read_b128 a[128:131], v3 offset:16384
 s_add_u32 m0, s95, 57344
 s_mov_b32 s94, 12288
 buffer_load_dwordx4 v27, s[36:39], m0 offen sc1 lds
 s_waitcnt lgkmcnt(5)
 v_mfma_f32_16x16x32_bf16 a[184:187], a[140:143], a[40:43], a[184:187]
 v_mfma_f32_16x16x32_bf16 a[188:191], a[140:143], a[44:47], a[188:191]
 ds_read_b128 a[132:135], v3 offset:17408
 buffer_load_dwordx4 v27, s[36:39], m0 offen offset:1024 sc1 lds
 s_waitcnt lgkmcnt(5)
 v_mfma_f32_16x16x32_bf16 a[176:179], a[144:147], a[48:51], a[176:179]
 v_mfma_f32_16x16x32_bf16 a[180:183], a[144:147], a[52:55], a[180:183]
 ds_read_b128 a[136:139], v3 offset:18432
 s_add_u32 m0, s95, 65536
 s_mov_b32 s94, 0
 buffer_load_dwordx4 v27, s[36:39], m0 offen sc1 lds
 s_waitcnt lgkmcnt(5)
 v_mfma_f32_16x16x32_bf16 a[184:187], a[148:151], a[48:51], a[184:187]
 v_mfma_f32_16x16x32_bf16 a[188:191], a[148:151], a[52:55], a[188:191]
 ds_read_b128 a[140:143], v3 offset:19456
 buffer_load_dwordx4 v27, s[36:39], m0 offen offset:1024 sc1 lds
 s_waitcnt lgkmcnt(5)
 v_mfma_f32_16x16x32_bf16 a[176:179], a[152:155], a[56:59], a[176:179]
 v_mfma_f32_16x16x32_bf16 a[180:183], a[152:155], a[60:63], a[180:183]
 ds_read_b128 a[144:147], v3 offset:20480
 s_add_u32 m0, s95, 73728
 s_mov_b32 s94, 4096
 buffer_load_dwordx4 v27, s[36:39], m0 offen sc1 lds
 s_waitcnt lgkmcnt(5)
 v_mfma_f32_16x16x32_bf16 a[184:187], a[156:159], a[56:59], a[184:187]
 v_mfma_f32_16x16x32_bf16 a[188:191], a[156:159], a[60:63], a[188:191]
 ds_read_b128 a[148:151], v3 offset:21504
 buffer_load_dwordx4 v27, s[36:39], m0 offen offset:1024 sc1 lds
 s_waitcnt lgkmcnt(5)
 v_mfma_f32_16x16x32_bf16 a[176:179], a[128:131], a[64:67], a[176:179]
 v_mfma_f32_16x16x32_bf16 a[180:183], a[128:131], a[68:71], a[180:183]
 ds_read_b128 a[152:155], v3 offset:22528
 s_add_u32 m0, s95, 81920
 s_mov_b32 s94, 8192
 buffer_load_dwordx4 v27, s[36:39], m0 offen sc1 lds
 s_waitcnt lgkmcnt(5)
 v_mfma_f32_16x16x32_bf16 a[184:187], a[132:135], a[64:67], a[184:187]
 v_mfma_f32_16x16x32_bf16 a[188:191], a[132:135], a[68:71], a[188:191]
 ds_read_b128 a[156:159], v3 offset:23552
 buffer_load_dwordx4 v27, s[36:39], m0 offen offset:1024 sc1 lds
 s_waitcnt vmcnt(14)
 s_barrier
 s_waitcnt lgkmcnt(5)
 v_mfma_f32_16x16x32_bf16 a[176:179], a[136:139], a[72:75], a[176:179]
 v_mfma_f32_16x16x32_bf16 a[180:183], a[136:139], a[76:79], a[180:183]
 ds_read_b128 a[128:131], v3 offset:24576
 s_add_u32 m0, s95, 90112
 s_mov_b32 s94, 12288
 buffer_load_dwordx4 v27, s[36:39], m0 offen sc1 lds
 s_waitcnt lgkmcnt(5)
 v_mfma_f32_16x16x32_bf16 a[184:187], a[140:143], a[72:75], a[184:187]
 v_mfma_f32_16x16x32_bf16 a[188:191], a[140:143], a[76:79], a[188:191]
 ds_read_b128 a[132:135], v3 offset:25600
 buffer_load_dwordx4 v27, s[36:39], m0 offen offset:1024 sc1 lds
 s_waitcnt lgkmcnt(5)
 v_mfma_f32_16x16x32_bf16 a[176:179], a[144:147], a[80:83], a[176:179]
 v_mfma_f32_16x16x32_bf16 a[180:183], a[144:147], a[84:87], a[180:183]
 ds_read_b128 a[136:139], v3 offset:26624
 s_waitcnt lgkmcnt(5)
 v_mfma_f32_16x16x32_bf16 a[184:187], a[148:151], a[80:83], a[184:187]
 v_mfma_f32_16x16x32_bf16 a[188:191], a[148:151], a[84:87], a[188:191]
 ds_read_b128 a[140:143], v3 offset:27648
 s_waitcnt lgkmcnt(5)
 v_mfma_f32_16x16x32_bf16 a[176:179], a[152:155], a[88:91], a[176:179]
 v_mfma_f32_16x16x32_bf16 a[180:183], a[152:155], a[92:95], a[180:183]
 ds_read_b128 a[144:147], v3 offset:28672
 s_waitcnt lgkmcnt(5)
 v_mfma_f32_16x16x32_bf16 a[184:187], a[156:159], a[88:91], a[184:187]
 v_mfma_f32_16x16x32_bf16 a[188:191], a[156:159], a[92:95], a[188:191]
 ds_read_b128 a[148:151], v3 offset:29696
 s_waitcnt lgkmcnt(5)
 v_mfma_f32_16x16x32_bf16 a[176:179], a[128:131], a[96:99], a[176:179]
 v_mfma_f32_16x16x32_bf16 a[180:183], a[128:131], a[100:103], a[180:183]
 ds_read_b128 a[152:155], v3 offset:30720
 s_waitcnt lgkmcnt(5)
 v_mfma_f32_16x16x32_bf16 a[184:187], a[132:135], a[96:99], a[184:187]
 v_mfma_f32_16x16x32_bf16 a[188:191], a[132:135], a[100:103], a[188:191]
 ds_read_b128 a[156:159], v3 offset:31744
 s_waitcnt vmcnt(8)
 s_barrier
 s_waitcnt lgkmcnt(5)
 v_mfma_f32_16x16x32_bf16 a[176:179], a[136:139], a[104:107], a[176:179]
 v_mfma_f32_16x16x32_bf16 a[180:183], a[136:139], a[108:111], a[180:183]
 ds_read_b128 a[128:131], v3 offset:32768
 s_waitcnt lgkmcnt(5)
 v_mfma_f32_16x16x32_bf16 a[184:187], a[140:143], a[104:107], a[184:187]
 v_mfma_f32_16x16x32_bf16 a[188:191], a[140:143], a[108:111], a[188:191]
 ds_read_b128 a[132:135], v3 offset:33792
 s_waitcnt lgkmcnt(5)
 v_mfma_f32_16x16x32_bf16 a[176:179], a[144:147], a[112:115], a[176:179]
 v_mfma_f32_16x16x32_bf16 a[180:183], a[144:147], a[116:119], a[180:183]
 ds_read_b128 a[136:139], v3 offset:34816
 s_waitcnt lgkmcnt(5)
 v_mfma_f32_16x16x32_bf16 a[184:187], a[148:151], a[112:115], a[184:187]
 v_mfma_f32_16x16x32_bf16 a[188:191], a[148:151], a[116:119], a[188:191]
 ds_read_b128 a[140:143], v3 offset:35840
 s_waitcnt lgkmcnt(5)
 v_mfma_f32_16x16x32_bf16 a[176:179], a[152:155], a[120:123], a[176:179]
 v_mfma_f32_16x16x32_bf16 a[180:183], a[152:155], a[124:127], a[180:183]
 ds_read_b128 a[144:147], v3 offset:36864
 s_waitcnt lgkmcnt(5)
 v_mfma_f32_16x16x32_bf16 a[184:187], a[156:159], a[120:123], a[184:187]
 v_mfma_f32_16x16x32_bf16 a[188:191], a[156:159], a[124:127], a[188:191]
 ds_read_b128 a[148:151], v3 offset:37888
 s_waitcnt lgkmcnt(5)
 v_mfma_f32_16x16x32_bf16 a[192:195], a[128:131], a[0:3], 0
 v_mfma_f32_16x16x32_bf16 a[196:199], a[128:131], a[4:7], 0
 ds_read_b128 a[152:155], v3 offset:38912
 s_waitcnt lgkmcnt(5)
 v_mfma_f32_16x16x32_bf16 a[200:203], a[132:135], a[0:3], 0
 v_mfma_f32_16x16x32_bf16 a[204:207], a[132:135], a[4:7], 0
 ds_read_b128 a[156:159], v3 offset:39936
 s_waitcnt lgkmcnt(5)
 v_mfma_f32_16x16x32_bf16 a[192:195], a[136:139], a[8:11], a[192:195]
 v_accvgpr_read_b32 v64, a176
 v_mfma_f32_16x16x32_bf16 a[196:199], a[136:139], a[12:15], a[196:199]
 v_accvgpr_read_b32 v65, a184
 ds_read_b128 a[128:131], v3 offset:40960
 s_waitcnt lgkmcnt(5)
 v_mfma_f32_16x16x32_bf16 a[200:203], a[140:143], a[8:11], a[200:203]
 v_accvgpr_read_b32 v66, a177
 v_mfma_f32_16x16x32_bf16 a[204:207], a[140:143], a[12:15], a[204:207]
 v_accvgpr_read_b32 v67, a185
 ds_read_b128 a[132:135], v3 offset:41984
 s_waitcnt lgkmcnt(5)
 v_mfma_f32_16x16x32_bf16 a[192:195], a[144:147], a[16:19], a[192:195]
 v_accvgpr_read_b32 v68, a178
 v_mfma_f32_16x16x32_bf16 a[196:199], a[144:147], a[20:23], a[196:199]
 v_accvgpr_read_b32 v69, a186
 ds_read_b128 a[136:139], v3 offset:43008
 s_waitcnt lgkmcnt(5)
 v_mfma_f32_16x16x32_bf16 a[200:203], a[148:151], a[16:19], a[200:203]
 v_accvgpr_read_b32 v70, a179
 v_mfma_f32_16x16x32_bf16 a[204:207], a[148:151], a[20:23], a[204:207]
 v_accvgpr_read_b32 v71, a187
 ds_read_b128 a[140:143], v3 offset:44032
 s_waitcnt lgkmcnt(5)
 v_mfma_f32_16x16x32_bf16 a[192:195], a[152:155], a[24:27], a[192:195]
 v_cvt_pk_bf16_f32 v80, v64, v65
 v_mfma_f32_16x16x32_bf16 a[196:199], a[152:155], a[28:31], a[196:199]
 v_cvt_pk_bf16_f32 v81, v66, v67
 ds_read_b128 a[144:147], v3 offset:45056
 s_waitcnt lgkmcnt(5)
 v_mfma_f32_16x16x32_bf16 a[200:203], a[156:159], a[24:27], a[200:203]
 v_cvt_pk_bf16_f32 v82, v68, v69
 v_mfma_f32_16x16x32_bf16 a[204:207], a[156:159], a[28:31], a[204:207]
 v_cvt_pk_bf16_f32 v83, v70, v71
 ds_read_b128 a[148:151], v3 offset:46080
 s_waitcnt lgkmcnt(5)
 v_mfma_f32_16x16x32_bf16 a[192:195], a[128:131], a[32:35], a[192:195]
 v_pk_max_i16 v80, v80, 0
 v_mfma_f32_16x16x32_bf16 a[196:199], a[128:131], a[36:39], a[196:199]
 v_pk_max_i16 v81, v81, 0
 ds_read_b128 a[152:155], v3 offset:47104
 s_waitcnt lgkmcnt(5)
 v_mfma_f32_16x16x32_bf16 a[200:203], a[132:135], a[32:35], a[200:203]
 v_pk_max_i16 v82, v82, 0
 v_mfma_f32_16x16x32_bf16 a[204:207], a[132:135], a[36:39], a[204:207]
 v_pk_max_i16 v83, v83, 0
 ds_read_b128 a[156:159], v3 offset:48128
 s_waitcnt lgkmcnt(5)
 v_mfma_f32_16x16x32_bf16 a[192:195], a[136:139], a[40:43], a[192:195]
 s_mov_b64 exec, s[96:97]
 buffer_store_dwordx4 v[80:83], v6, s[36:39], 0 offen offset:0 sc1
 s_mov_b64 exec, -1
 v_mfma_f32_16x16x32_bf16 a[196:199], a[136:139], a[44:47], a[196:199]
 v_accvgpr_read_b32 v64, a180
 ds_read_b128 a[128:131], v3 offset:49152
 s_waitcnt lgkmcnt(5)
 v_mfma_f32_16x16x32_bf16 a[200:203], a[140:143], a[40:43], a[200:203]
 v_accvgpr_read_b32 v65, a188
 v_mfma_f32_16x16x32_bf16 a[204:207], a[140:143], a[44:47], a[204:207]
 v_accvgpr_read_b32 v66, a181
 ds_read_b128 a[132:135], v3 offset:50176
 s_waitcnt lgkmcnt(5)
 v_mfma_f32_16x16x32_bf16 a[192:195], a[144:147], a[48:51], a[192:195]
 v_accvgpr_read_b32 v67, a189
 v_mfma_f32_16x16x32_bf16 a[196:199], a[144:147], a[52:55], a[196:199]
 v_accvgpr_read_b32 v68, a182
 ds_read_b128 a[136:139], v3 offset:51200
 s_waitcnt lgkmcnt(5)
 v_mfma_f32_16x16x32_bf16 a[200:203], a[148:151], a[48:51], a[200:203]
 v_accvgpr_read_b32 v69, a190
 v_mfma_f32_16x16x32_bf16 a[204:207], a[148:151], a[52:55], a[204:207]
 v_accvgpr_read_b32 v70, a183
 ds_read_b128 a[140:143], v3 offset:52224
 s_waitcnt lgkmcnt(5)
 v_mfma_f32_16x16x32_bf16 a[192:195], a[152:155], a[56:59], a[192:195]
 v_accvgpr_read_b32 v71, a191
 v_mfma_f32_16x16x32_bf16 a[196:199], a[152:155], a[60:63], a[196:199]
 v_cvt_pk_bf16_f32 v84, v64, v65
 ds_read_b128 a[144:147], v3 offset:53248
 s_waitcnt lgkmcnt(5)
 v_mfma_f32_16x16x32_bf16 a[200:203], a[156:159], a[56:59], a[200:203]
 v_cvt_pk_bf16_f32 v85, v66, v67
 v_mfma_f32_16x16x32_bf16 a[204:207], a[156:159], a[60:63], a[204:207]
 v_cvt_pk_bf16_f32 v86, v68, v69
 ds_read_b128 a[148:151], v3 offset:54272
 s_waitcnt lgkmcnt(5)
 v_mfma_f32_16x16x32_bf16 a[192:195], a[128:131], a[64:67], a[192:195]
 v_cvt_pk_bf16_f32 v87, v70, v71
 v_mfma_f32_16x16x32_bf16 a[196:199], a[128:131], a[68:71], a[196:199]
 v_pk_max_i16 v84, v84, 0
 ds_read_b128 a[152:155], v3 offset:55296
 s_waitcnt lgkmcnt(5)
 v_mfma_f32_16x16x32_bf16 a[200:203], a[132:135], a[64:67], a[200:203]
 v_pk_max_i16 v85, v85, 0
 v_mfma_f32_16x16x32_bf16 a[204:207], a[132:135], a[68:71], a[204:207]
 v_pk_max_i16 v86, v86, 0
 ds_read_b128 a[156:159], v3 offset:56320
 s_waitcnt lgkmcnt(5)
 v_mfma_f32_16x16x32_bf16 a[192:195], a[136:139], a[72:75], a[192:195]
 v_pk_max_i16 v87, v87, 0
 v_mfma_f32_16x16x32_bf16 a[196:199], a[136:139], a[76:79], a[196:199]
 s_mov_b64 exec, s[96:97]
 buffer_store_dwordx4 v[84:87], v7, s[36:39], 0 offen offset:0 sc1
 s_mov_b64 exec, -1
 ds_read_b128 a[128:131], v3 offset:57344
 s_waitcnt lgkmcnt(5)
 v_mfma_f32_16x16x32_bf16 a[200:203], a[140:143], a[72:75], a[200:203]
 v_mfma_f32_16x16x32_bf16 a[204:207], a[140:143], a[76:79], a[204:207]
 ds_read_b128 a[132:135], v3 offset:58368
 s_waitcnt lgkmcnt(5)
 v_mfma_f32_16x16x32_bf16 a[192:195], a[144:147], a[80:83], a[192:195]
 v_mfma_f32_16x16x32_bf16 a[196:199], a[144:147], a[84:87], a[196:199]
 ds_read_b128 a[136:139], v3 offset:59392
 s_waitcnt lgkmcnt(5)
 v_mfma_f32_16x16x32_bf16 a[200:203], a[148:151], a[80:83], a[200:203]
 v_mfma_f32_16x16x32_bf16 a[204:207], a[148:151], a[84:87], a[204:207]
 ds_read_b128 a[140:143], v3 offset:60416
 s_waitcnt lgkmcnt(5)
 v_mfma_f32_16x16x32_bf16 a[192:195], a[152:155], a[88:91], a[192:195]
 v_mfma_f32_16x16x32_bf16 a[196:199], a[152:155], a[92:95], a[196:199]
 ds_read_b128 a[144:147], v3 offset:61440
 s_waitcnt lgkmcnt(5)
 v_mfma_f32_16x16x32_bf16 a[200:203], a[156:159], a[88:91], a[200:203]
 v_mfma_f32_16x16x32_bf16 a[204:207], a[156:159], a[92:95], a[204:207]
 ds_read_b128 a[148:151], v3 offset:62464
 s_waitcnt lgkmcnt(5)
 v_mfma_f32_16x16x32_bf16 a[192:195], a[128:131], a[96:99], a[192:195]
 v_mfma_f32_16x16x32_bf16 a[196:199], a[128:131], a[100:103], a[196:199]
 ds_read_b128 a[152:155], v3 offset:63488
 s_waitcnt lgkmcnt(5)
 v_mfma_f32_16x16x32_bf16 a[200:203], a[132:135], a[96:99], a[200:203]
 v_mfma_f32_16x16x32_bf16 a[204:207], a[132:135], a[100:103], a[204:207]
 ds_read_b128 a[156:159], v3 offset:64512
 s_waitcnt vmcnt(2)
 s_barrier
 s_waitcnt lgkmcnt(5)
 v_mfma_f32_16x16x32_bf16 a[192:195], a[136:139], a[104:107], a[192:195]
 v_mfma_f32_16x16x32_bf16 a[196:199], a[136:139], a[108:111], a[196:199]
 ds_read_b128 a[128:131], v26 offset:0
 s_waitcnt lgkmcnt(5)
 v_mfma_f32_16x16x32_bf16 a[200:203], a[140:143], a[104:107], a[200:203]
 v_mfma_f32_16x16x32_bf16 a[204:207], a[140:143], a[108:111], a[204:207]
 ds_read_b128 a[132:135], v26 offset:1024
 s_waitcnt lgkmcnt(5)
 v_mfma_f32_16x16x32_bf16 a[192:195], a[144:147], a[112:115], a[192:195]
 v_mfma_f32_16x16x32_bf16 a[196:199], a[144:147], a[116:119], a[196:199]
 ds_read_b128 a[136:139], v26 offset:2048
 s_waitcnt lgkmcnt(5)
 v_mfma_f32_16x16x32_bf16 a[200:203], a[148:151], a[112:115], a[200:203]
 v_mfma_f32_16x16x32_bf16 a[204:207], a[148:151], a[116:119], a[204:207]
 ds_read_b128 a[140:143], v26 offset:3072
 s_waitcnt lgkmcnt(5)
 v_mfma_f32_16x16x32_bf16 a[192:195], a[152:155], a[120:123], a[192:195]
 v_mfma_f32_16x16x32_bf16 a[196:199], a[152:155], a[124:127], a[196:199]
 ds_read_b128 a[144:147], v26 offset:4096
 s_waitcnt lgkmcnt(5)
 v_mfma_f32_16x16x32_bf16 a[200:203], a[156:159], a[120:123], a[200:203]
 v_mfma_f32_16x16x32_bf16 a[204:207], a[156:159], a[124:127], a[204:207]
 ds_read_b128 a[148:151], v26 offset:5120
 s_waitcnt lgkmcnt(5)
 v_mfma_f32_16x16x32_bf16 a[208:211], a[128:131], a[0:3], 0
 v_mfma_f32_16x16x32_bf16 a[212:215], a[128:131], a[4:7], 0
 ds_read_b128 a[152:155], v26 offset:6144
 s_waitcnt lgkmcnt(5)
 v_mfma_f32_16x16x32_bf16 a[216:219], a[132:135], a[0:3], 0
 v_mfma_f32_16x16x32_bf16 a[220:223], a[132:135], a[4:7], 0
 ds_read_b128 a[156:159], v26 offset:7168
 s_waitcnt lgkmcnt(5)
 v_mfma_f32_16x16x32_bf16 a[208:211], a[136:139], a[8:11], a[208:211]
 v_accvgpr_read_b32 v64, a192
 v_mfma_f32_16x16x32_bf16 a[212:215], a[136:139], a[12:15], a[212:215]
 v_accvgpr_read_b32 v65, a200
 ds_read_b128 a[128:131], v26 offset:8192
 s_waitcnt lgkmcnt(5)
 v_mfma_f32_16x16x32_bf16 a[216:219], a[140:143], a[8:11], a[216:219]
 v_accvgpr_read_b32 v66, a193
 v_mfma_f32_16x16x32_bf16 a[220:223], a[140:143], a[12:15], a[220:223]
 v_accvgpr_read_b32 v67, a201
 ds_read_b128 a[132:135], v26 offset:9216
 s_waitcnt lgkmcnt(5)
 v_mfma_f32_16x16x32_bf16 a[208:211], a[144:147], a[16:19], a[208:211]
 v_accvgpr_read_b32 v68, a194
 v_mfma_f32_16x16x32_bf16 a[212:215], a[144:147], a[20:23], a[212:215]
 v_accvgpr_read_b32 v69, a202
 ds_read_b128 a[136:139], v26 offset:10240
 s_waitcnt lgkmcnt(5)
 v_mfma_f32_16x16x32_bf16 a[216:219], a[148:151], a[16:19], a[216:219]
 v_accvgpr_read_b32 v70, a195
 v_mfma_f32_16x16x32_bf16 a[220:223], a[148:151], a[20:23], a[220:223]
 v_accvgpr_read_b32 v71, a203
 ds_read_b128 a[140:143], v26 offset:11264
 s_waitcnt lgkmcnt(5)
 v_mfma_f32_16x16x32_bf16 a[208:211], a[152:155], a[24:27], a[208:211]
 v_cvt_pk_bf16_f32 v88, v64, v65
 v_mfma_f32_16x16x32_bf16 a[212:215], a[152:155], a[28:31], a[212:215]
 v_cvt_pk_bf16_f32 v89, v66, v67
 ds_read_b128 a[144:147], v26 offset:12288
 s_waitcnt lgkmcnt(5)
 v_mfma_f32_16x16x32_bf16 a[216:219], a[156:159], a[24:27], a[216:219]
 v_cvt_pk_bf16_f32 v90, v68, v69
 v_mfma_f32_16x16x32_bf16 a[220:223], a[156:159], a[28:31], a[220:223]
 v_cvt_pk_bf16_f32 v91, v70, v71
 ds_read_b128 a[148:151], v26 offset:13312
 s_waitcnt lgkmcnt(5)
 v_mfma_f32_16x16x32_bf16 a[208:211], a[128:131], a[32:35], a[208:211]
 v_pk_max_i16 v88, v88, 0
 v_mfma_f32_16x16x32_bf16 a[212:215], a[128:131], a[36:39], a[212:215]
 v_pk_max_i16 v89, v89, 0
 ds_read_b128 a[152:155], v26 offset:14336
 s_waitcnt lgkmcnt(5)
 v_mfma_f32_16x16x32_bf16 a[216:219], a[132:135], a[32:35], a[216:219]
 v_pk_max_i16 v90, v90, 0
 v_mfma_f32_16x16x32_bf16 a[220:223], a[132:135], a[36:39], a[220:223]
 v_pk_max_i16 v91, v91, 0
 ds_read_b128 a[156:159], v26 offset:15360
 s_waitcnt lgkmcnt(5)
 v_mfma_f32_16x16x32_bf16 a[208:211], a[136:139], a[40:43], a[208:211]
 s_mov_b64 exec, s[96:97]
 buffer_store_dwordx4 v[88:91], v6, s[36:39], 0 offen offset:1024 sc1
 s_mov_b64 exec, -1
 v_mfma_f32_16x16x32_bf16 a[212:215], a[136:139], a[44:47], a[212:215]
 v_accvgpr_read_b32 v64, a196
 ds_read_b128 a[128:131], v26 offset:16384
 s_waitcnt lgkmcnt(5)
 v_mfma_f32_16x16x32_bf16 a[216:219], a[140:143], a[40:43], a[216:219]
 v_accvgpr_read_b32 v65, a204
 v_mfma_f32_16x16x32_bf16 a[220:223], a[140:143], a[44:47], a[220:223]
 v_accvgpr_read_b32 v66, a197
 ds_read_b128 a[132:135], v26 offset:17408
 s_waitcnt lgkmcnt(5)
 v_mfma_f32_16x16x32_bf16 a[208:211], a[144:147], a[48:51], a[208:211]
 v_accvgpr_read_b32 v67, a205
 v_mfma_f32_16x16x32_bf16 a[212:215], a[144:147], a[52:55], a[212:215]
 v_accvgpr_read_b32 v68, a198
 ds_read_b128 a[136:139], v26 offset:18432
 s_waitcnt lgkmcnt(5)
 v_mfma_f32_16x16x32_bf16 a[216:219], a[148:151], a[48:51], a[216:219]
 v_accvgpr_read_b32 v69, a206
 v_mfma_f32_16x16x32_bf16 a[220:223], a[148:151], a[52:55], a[220:223]
 v_accvgpr_read_b32 v70, a199
 ds_read_b128 a[140:143], v26 offset:19456
 s_waitcnt lgkmcnt(5)
 v_mfma_f32_16x16x32_bf16 a[208:211], a[152:155], a[56:59], a[208:211]
 v_accvgpr_read_b32 v71, a207
 v_mfma_f32_16x16x32_bf16 a[212:215], a[152:155], a[60:63], a[212:215]
 v_cvt_pk_bf16_f32 v92, v64, v65
 ds_read_b128 a[144:147], v26 offset:20480
 s_waitcnt lgkmcnt(5)
 v_mfma_f32_16x16x32_bf16 a[216:219], a[156:159], a[56:59], a[216:219]
 v_cvt_pk_bf16_f32 v93, v66, v67
 v_mfma_f32_16x16x32_bf16 a[220:223], a[156:159], a[60:63], a[220:223]
 v_cvt_pk_bf16_f32 v94, v68, v69
 ds_read_b128 a[148:151], v26 offset:21504
 s_waitcnt lgkmcnt(5)
 v_mfma_f32_16x16x32_bf16 a[208:211], a[128:131], a[64:67], a[208:211]
 v_cvt_pk_bf16_f32 v95, v70, v71
 v_mfma_f32_16x16x32_bf16 a[212:215], a[128:131], a[68:71], a[212:215]
 v_pk_max_i16 v92, v92, 0
 ds_read_b128 a[152:155], v26 offset:22528
 s_waitcnt lgkmcnt(5)
 v_mfma_f32_16x16x32_bf16 a[216:219], a[132:135], a[64:67], a[216:219]
 v_pk_max_i16 v93, v93, 0
 v_mfma_f32_16x16x32_bf16 a[220:223], a[132:135], a[68:71], a[220:223]
 v_pk_max_i16 v94, v94, 0
 ds_read_b128 a[156:159], v26 offset:23552
 s_waitcnt lgkmcnt(5)
 v_mfma_f32_16x16x32_bf16 a[208:211], a[136:139], a[72:75], a[208:211]
 v_pk_max_i16 v95, v95, 0
 v_mfma_f32_16x16x32_bf16 a[212:215], a[136:139], a[76:79], a[212:215]
 s_mov_b64 exec, s[96:97]
 buffer_store_dwordx4 v[92:95], v7, s[36:39], 0 offen offset:1024 sc1
 s_mov_b64 exec, -1
 ds_read_b128 a[128:131], v26 offset:24576
 s_waitcnt lgkmcnt(5)
 v_mfma_f32_16x16x32_bf16 a[216:219], a[140:143], a[72:75], a[216:219]
 v_mfma_f32_16x16x32_bf16 a[220:223], a[140:143], a[76:79], a[220:223]
 ds_read_b128 a[132:135], v26 offset:25600
 s_waitcnt lgkmcnt(5)
 v_mfma_f32_16x16x32_bf16 a[208:211], a[144:147], a[80:83], a[208:211]
 v_mfma_f32_16x16x32_bf16 a[212:215], a[144:147], a[84:87], a[212:215]
 ds_read_b128 a[136:139], v26 offset:26624
 s_waitcnt lgkmcnt(5)
 v_mfma_f32_16x16x32_bf16 a[216:219], a[148:151], a[80:83], a[216:219]
 v_mfma_f32_16x16x32_bf16 a[220:223], a[148:151], a[84:87], a[220:223]
 ds_read_b128 a[140:143], v26 offset:27648
 s_waitcnt lgkmcnt(5)
 v_mfma_f32_16x16x32_bf16 a[208:211], a[152:155], a[88:91], a[208:211]
 v_mfma_f32_16x16x32_bf16 a[212:215], a[152:155], a[92:95], a[212:215]
 ds_read_b128 a[144:147], v26 offset:28672
 s_waitcnt lgkmcnt(5)
 v_mfma_f32_16x16x32_bf16 a[216:219], a[156:159], a[88:91], a[216:219]
 v_mfma_f32_16x16x32_bf16 a[220:223], a[156:159], a[92:95], a[220:223]
 ds_read_b128 a[148:151], v26 offset:29696
 s_waitcnt lgkmcnt(5)
 v_mfma_f32_16x16x32_bf16 a[208:211], a[128:131], a[96:99], a[208:211]
 v_mfma_f32_16x16x32_bf16 a[212:215], a[128:131], a[100:103], a[212:215]
 ds_read_b128 a[152:155], v26 offset:30720
 s_waitcnt lgkmcnt(5)
 v_mfma_f32_16x16x32_bf16 a[216:219], a[132:135], a[96:99], a[216:219]
 v_mfma_f32_16x16x32_bf16 a[220:223], a[132:135], a[100:103], a[220:223]
 ds_read_b128 a[156:159], v26 offset:31744
 s_waitcnt lgkmcnt(5)
 v_mfma_f32_16x16x32_bf16 a[208:211], a[136:139], a[104:107], a[208:211]
 v_mfma_f32_16x16x32_bf16 a[212:215], a[136:139], a[108:111], a[212:215]
 s_waitcnt lgkmcnt(4)
 v_mfma_f32_16x16x32_bf16 a[216:219], a[140:143], a[104:107], a[216:219]
 v_mfma_f32_16x16x32_bf16 a[220:223], a[140:143], a[108:111], a[220:223]
 s_waitcnt lgkmcnt(3)
 v_mfma_f32_16x16x32_bf16 a[208:211], a[144:147], a[112:115], a[208:211]
 v_mfma_f32_16x16x32_bf16 a[212:215], a[144:147], a[116:119], a[212:215]
 s_waitcnt lgkmcnt(2)
 v_mfma_f32_16x16x32_bf16 a[216:219], a[148:151], a[112:115], a[216:219]
 v_mfma_f32_16x16x32_bf16 a[220:223], a[148:151], a[116:119], a[220:223]
 s_waitcnt lgkmcnt(1)
 v_mfma_f32_16x16x32_bf16 a[208:211], a[152:155], a[120:123], a[208:211]
 v_mfma_f32_16x16x32_bf16 a[212:215], a[152:155], a[124:127], a[212:215]
 s_waitcnt lgkmcnt(0)
 v_mfma_f32_16x16x32_bf16 a[216:219], a[156:159], a[120:123], a[216:219]
 v_mfma_f32_16x16x32_bf16 a[220:223], a[156:159], a[124:127], a[220:223]
 s_nop 7
 s_nop 7
 v_accvgpr_read_b32 v64, a208
 v_accvgpr_read_b32 v65, a216
 v_accvgpr_read_b32 v66, a209
 v_accvgpr_read_b32 v67, a217
 v_accvgpr_read_b32 v68, a210
 v_accvgpr_read_b32 v69, a218
 v_accvgpr_read_b32 v70, a211
 v_accvgpr_read_b32 v71, a219
 v_cvt_pk_bf16_f32 v80, v64, v65
 v_cvt_pk_bf16_f32 v81, v66, v67
 v_cvt_pk_bf16_f32 v82, v68, v69
 v_cvt_pk_bf16_f32 v83, v70, v71
 v_pk_max_i16 v80, v80, 0
 v_pk_max_i16 v81, v81, 0
 v_pk_max_i16 v82, v82, 0
 v_pk_max_i16 v83, v83, 0
 s_mov_b64 exec, s[98:99]
 buffer_store_dwordx4 v[80:83], v6, s[36:39], 0 offen offset:2048 sc1
 s_mov_b64 exec, -1
 v_accvgpr_read_b32 v64, a212
 v_accvgpr_read_b32 v65, a220
 v_accvgpr_read_b32 v66, a213
 v_accvgpr_read_b32 v67, a221
 v_accvgpr_read_b32 v68, a214
 v_accvgpr_read_b32 v69, a222
 v_accvgpr_read_b32 v70, a215
 v_accvgpr_read_b32 v71, a223
 v_cvt_pk_bf16_f32 v84, v64, v65
 v_cvt_pk_bf16_f32 v85, v66, v67
 v_cvt_pk_bf16_f32 v86, v68, v69
 v_cvt_pk_bf16_f32 v87, v70, v71
 v_pk_max_i16 v84, v84, 0
 v_pk_max_i16 v85, v85, 0
 v_pk_max_i16 v86, v86, 0
 v_pk_max_i16 v87, v87, 0
 s_mov_b64 exec, s[98:99]
 buffer_store_dwordx4 v[84:87], v7, s[36:39], 0 offen offset:2048 sc1
 s_mov_b64 exec, -1
 ds_read2_b32 a[192:193], v16 offset0:48 offset1:49
 ds_read2_b32 a[194:195], v16 offset0:50 offset1:51
 ds_read_b128 a[224:227], v21 offset:3776
 ds_read_b128 a[228:231], v21 offset:3264
 ds_read_b128 a[232:235], v21 offset:2752
 ds_read_b128 a[236:239], v21 offset:2240
 ds_read_b128 a[240:243], v21 offset:1728
 ds_read_b128 a[244:247], v21 offset:1216
 ds_read_b128 a[248:251], v21 offset:704
 ds_read_b128 a[252:255], v21 offset:192
 ds_read2_b32 a[196:197], v16 offset0:176 offset1:177
 ds_read2_b32 a[198:199], v16 offset0:178 offset1:179
 ds_read2_b32 a[200:201], v17 offset0:48 offset1:49
 ds_read2_b32 a[202:203], v17 offset0:50 offset1:51
 ds_read2_b32 a[204:205], v17 offset0:176 offset1:177
 ds_read2_b32 a[206:207], v17 offset0:178 offset1:179
 ds_read2_b32 a[208:209], v18 offset0:48 offset1:49
 ds_read2_b32 a[210:211], v18 offset0:50 offset1:51
 ds_read2_b32 a[212:213], v18 offset0:176 offset1:177
 ds_read2_b32 a[214:215], v18 offset0:178 offset1:179
 ds_read2_b32 a[216:217], v19 offset0:48 offset1:49
 ds_read2_b32 a[218:219], v19 offset0:50 offset1:51
 ds_read2_b32 a[220:221], v19 offset0:176 offset1:177
 ds_read2_b32 a[222:223], v19 offset0:178 offset1:179
 s_waitcnt lgkmcnt(14)
 v_mfma_f32_16x16x32_bf16 v[32:35], a[192:195], a[224:227], v[32:35]
 v_mfma_f32_16x16x32_bf16 v[36:39], a[192:195], a[228:231], v[36:39]
 v_mfma_f32_16x16x32_bf16 v[40:43], a[192:195], a[232:235], v[40:43]
 v_mfma_f32_16x16x32_bf16 v[44:47], a[192:195], a[236:239], v[44:47]
 v_mfma_f32_16x16x32_bf16 v[48:51], a[192:195], a[240:243], v[48:51]
 v_mfma_f32_16x16x32_bf16 v[52:55], a[192:195], a[244:247], v[52:55]
 v_mfma_f32_16x16x32_bf16 v[56:59], a[192:195], a[248:251], v[56:59]
 v_mfma_f32_16x16x32_bf16 v[60:63], a[192:195], a[252:255], v[60:63]
 s_waitcnt lgkmcnt(12)
 v_mfma_f32_16x16x32_bf16 v[36:39], a[196:199], a[224:227], v[36:39]
 v_mfma_f32_16x16x32_bf16 v[40:43], a[196:199], a[228:231], v[40:43]
 v_mfma_f32_16x16x32_bf16 v[44:47], a[196:199], a[232:235], v[44:47]
 v_mfma_f32_16x16x32_bf16 v[48:51], a[196:199], a[236:239], v[48:51]
 v_mfma_f32_16x16x32_bf16 v[52:55], a[196:199], a[240:243], v[52:55]
 v_mfma_f32_16x16x32_bf16 v[56:59], a[196:199], a[244:247], v[56:59]
 v_mfma_f32_16x16x32_bf16 v[60:63], a[196:199], a[248:251], v[60:63]
 s_waitcnt lgkmcnt(0)
 v_mfma_f32_16x16x32_bf16 v[40:43], a[200:203], a[224:227], v[40:43]
 ds_read_b64 v[104:105], v23 offset:1536
 ds_read_b64 v[106:107], v23 offset:1024
 v_mfma_f32_16x16x32_bf16 v[44:47], a[200:203], a[228:231], v[44:47]
 ds_read_b64 v[108:109], v23 offset:512
 ds_read_b64 v[110:111], v23 offset:0
 v_mfma_f32_16x16x32_bf16 v[48:51], a[200:203], a[232:235], v[48:51]
 v_mfma_f32_16x16x32_bf16 v[52:55], a[200:203], a[236:239], v[52:55]
 v_mfma_f32_16x16x32_bf16 v[56:59], a[200:203], a[240:243], v[56:59]
 v_mfma_f32_16x16x32_bf16 v[60:63], a[200:203], a[244:247], v[60:63]
 v_mfma_f32_16x16x32_bf16 v[44:47], a[204:207], a[224:227], v[44:47]
 v_mfma_f32_16x16x32_bf16 v[48:51], a[204:207], a[228:231], v[48:51]
 v_mfma_f32_16x16x32_bf16 v[52:55], a[204:207], a[232:235], v[52:55]
 v_mfma_f32_16x16x32_bf16 v[56:59], a[204:207], a[236:239], v[56:59]
 v_mfma_f32_16x16x32_bf16 v[60:63], a[204:207], a[240:243], v[60:63]
 v_mfma_f32_16x16x32_bf16 v[48:51], a[208:211], a[224:227], v[48:51]
 v_mfma_f32_16x16x32_bf16 v[52:55], a[208:211], a[228:231], v[52:55]
 v_mfma_f32_16x16x32_bf16 v[56:59], a[208:211], a[232:235], v[56:59]
 v_mfma_f32_16x16x32_bf16 v[60:63], a[208:211], a[236:239], v[60:63]
 v_mfma_f32_16x16x32_bf16 v[52:55], a[212:215], a[224:227], v[52:55]
 v_mfma_f32_16x16x32_bf16 v[56:59], a[212:215], a[228:231], v[56:59]
 v_mfma_f32_16x16x32_bf16 v[60:63], a[212:215], a[232:235], v[60:63]
 v_mfma_f32_16x16x32_bf16 v[56:59], a[216:219], a[224:227], v[56:59]
 v_mfma_f32_16x16x32_bf16 v[60:63], a[216:219], a[228:231], v[60:63]
 v_mfma_f32_16x16x32_bf16 v[60:63], a[220:223], a[224:227], v[60:63]
 s_cmp_eq_u32 s58, 0
 s_cbranch_scc1 k2_h0
 s_nop 4
 ds_write_b128 v24, v[32:35] offset:0
 ds_write_b128 v24, v[36:39] offset:1024
 ds_write_b128 v24, v[40:43] offset:2048
 ds_write_b128 v24, v[44:47] offset:3072
 s_nop 1
 v_mov_b32 v32, v48
 v_mov_b32 v33, v49
 v_mov_b32 v34, v50
 v_mov_b32 v35, v51
 v_mov_b32 v36, v52
 v_mov_b32 v37, v53
 v_mov_b32 v38, v54
 v_mov_b32 v39, v55
 v_mov_b32 v40, v56
 v_mov_b32 v41, v57
 v_mov_b32 v42, v58
 v_mov_b32 v43, v59
 v_mov_b32 v44, v60
 v_mov_b32 v45, v61
 v_mov_b32 v46, v62
 v_mov_b32 v47, v63
 s_branch k2_h1
k2_h0:
 s_nop 4
 ds_write_b128 v24, v[48:51] offset:0
 ds_write_b128 v24, v[52:55] offset:1024
 ds_write_b128 v24, v[56:59] offset:2048
 ds_write_b128 v24, v[60:63] offset:3072
k2_h1:
 v_add_u32 v11, 3072, v11
 s_mul_i32 s91, s55, 172
 s_mul_i32 s92, s3, 11
 s_add_u32 s91, s91, s92
 s_lshl_b32 s91, s91, 10
 s_add_u32 s91, s91, 8388608
 v_add_u32 v4, s91, v3
 v_add_u32 v5, 43*1024, v4
 v_add_u32 v6, 86*1024, v4
 v_add_u32 v7, 129*1024, v4
 s_lshr_b32 s91, s55, 1
 s_lshl_b32 s91, s91, 7
 s_add_u32 s91, s91, 14683136
 v_lshlrev_b32 v20, 2, v13
 v_add_u32 v20, s91, v20
 s_lshl_b32 s91, s56, 7
 s_add_u32 s91, s91, 14685184
 v_and_b32 v21, 31, v2
 v_lshlrev_b32 v21, 2, v21
 v_add_u32 v21, s91, v21
 s_lshl_b32 s94, s55, 2
 s_add_u32 s94, s94, s3
 s_lshl_b32 s95, s94, 14
 s_lshl_b32 s91, s56, 7
 s_add_u32 s91, s91, s95
 v_lshlrev_b32 v10, 12, v14
 v_lshl_add_u32 v10, v13, 3, v10
 v_add_u32 v10, s91, v10
 s_lshl_b32 s91, s56, 11
 s_add_u32 s91, s91, s95
 v_lshrrev_b32 v17, 1, v13
 v_lshlrev_b32 v17, 8, v17
 v_and_b32 v12, 1, v13
 v_lshl_add_u32 v17, v12, 3, v17
 v_lshl_add_u32 v17, v14, 6, v17
 v_add_u32 v17, s91, v17
 s_lshl_b32 s91, s56, 18
 s_lshl_b32 s95, s94, 5
 s_add_u32 s91, s91, s95
 s_add_u32 s91, s91, 6291456
 v_lshlrev_b32 v12, 14, v13
 v_lshl_add_u32 v12, v14, 3, v12
 v_add_u32 v12, s91, v12
 s_mov_b32 s98, 8192
 s_mov_b32 s99, 12288
 s_mul_i32 s91, s3, 16*1040
 v_add_u32 v15, s91, v3
 v_lshrrev_b32 v16, 2, v13
 v_mul_u32_u24 v16, 1040, v16
 v_and_b32 v18, 3, v13
 v_lshl_add_u32 v16, v18, 6, v16
 v_lshl_add_u32 v16, v14, 8, v16
 s_mul_i32 s91, s3, 4*1040
 v_add_u32 v16, s91, v16
 s_waitcnt vmcnt(0) lgkmcnt(0)
 s_barrier
 s_cmp_lg_u32 s3, 0
 s_cbranch_scc1 sig1
 s_mov_b64 exec, 1
 buffer_store_dword v31, v11, s[36:39], 0 offen sc1
 s_mov_b64 exec, -1
sig1:
 ds_read_b128 v[64:67], v25 offset:0
 ds_read_b128 v[68:71], v25 offset:1024
 ds_read_b128 v[72:75], v25 offset:2048
 ds_read_b128 v[76:79], v25 offset:3072
 s_add_u32 m0, s63, 16384
 s_mov_b32 s91, 196608
 buffer_load_dwordx4 v8, s[28:31], s91 offen lds
 s_add_u32 m0, s63, 17408
 s_mov_b32 s91, 204800
 buffer_load_dwordx4 v9, s[28:31], s91 offen lds
 s_add_u32 m0, s63, 18432
 s_mov_b32 s91, 212992
 buffer_load_dwordx4 v8, s[28:31], s91 offen lds
 s_add_u32 m0, s63, 19456
 s_mov_b32 s91, 221184
 buffer_load_dwordx4 v9, s[28:31], s91 offen lds
 s_waitcnt lgkmcnt(0)
 v_pk_add_f32 v[32:33], v[32:33], v[64:65]
 v_pk_add_f32 v[34:35], v[34:35], v[66:67]
 v_and_b32 v88, s40, v105
 s_add_u32 m0, s63, 32768
 s_mov_b32 s91, 229376
 buffer_load_dwordx4 v8, s[28:31], s91 offen lds
 v_lshlrev_b32 v89, 16, v105
 v_and_b32 v90, s40, v104
 v_lshlrev_b32 v91, 16, v104
 s_add_u32 m0, s63, 33792
 s_mov_b32 s91, 237568
 buffer_load_dwordx4 v9, s[28:31], s91 offen lds
 v_mul_f32 v88, s93, v88
 v_mul_f32 v89, s93, v89
 v_mul_f32 v90, s93, v90
 s_add_u32 m0, s63, 34816
 s_mov_b32 s91, 245760
 buffer_load_dwordx4 v8, s[28:31], s91 offen lds
 v_mul_f32 v91, s93, v91
 v_cvt_pk_bf16_f32 v92, v32, v33
 v_lshlrev_b32 v32, 16, v92
 s_add_u32 m0, s63, 35840
 s_mov_b32 s91, 253952
 buffer_load_dwordx4 v9, s[28:31], s91 offen lds
 v_and_b32 v33, s40, v92
 v_cvt_pk_bf16_f32 v92, v34, v35
 v_lshlrev_b32 v34, 16, v92
 s_add_u32 m0, s63, 49152
 s_mov_b32 s91, 262144
 buffer_load_dwordx4 v8, s[28:31], s91 offen lds
 v_and_b32 v35, s40, v92
 v_cvt_pk_bf16_f32 v92, v88, v89
 v_lshlrev_b32 v88, 16, v92
 s_add_u32 m0, s63, 50176
 s_mov_b32 s91, 270336
 buffer_load_dwordx4 v9, s[28:31], s91 offen lds
 v_and_b32 v89, s40, v92
 v_cvt_pk_bf16_f32 v92, v90, v91
 v_lshlrev_b32 v90, 16, v92
 s_add_u32 m0, s63, 51200
 s_mov_b32 s91, 278528
 buffer_load_dwordx4 v8, s[28:31], s91 offen lds
 v_and_b32 v91, s40, v92
 v_add_f32 v32, v32, v88
 v_add_f32 v33, v33, v89
 s_add_u32 m0, s63, 52224
 s_mov_b32 s91, 286720
 buffer_load_dwordx4 v9, s[28:31], s91 offen lds
 v_add_f32 v34, v34, v90
 v_add_f32 v35, v35, v91
 v_cvt_pk_bf16_f32 v96, v32, v33
 v_cvt_pk_bf16_f32 v97, v34, v35
 buffer_store_dwordx2 v[96:97], v22, s[36:39], 0 offen offset:0 sc1
 v_pk_add_f32 v[36:37], v[36:37], v[68:69]
 v_pk_add_f32 v[38:39], v[38:39], v[70:71]
 v_and_b32 v88, s40, v107
 v_lshlrev_b32 v89, 16, v107
 v_and_b32 v90, s40, v106
 v_lshlrev_b32 v91, 16, v106
 v_mul_f32 v88, s93, v88
 v_mul_f32 v89, s93, v89
 v_mul_f32 v90, s93, v90
 v_mul_f32 v91, s93, v91
 v_cvt_pk_bf16_f32 v92, v36, v37
 v_lshlrev_b32 v36, 16, v92
 v_and_b32 v37, s40, v92
 v_cvt_pk_bf16_f32 v92, v38, v39
 v_lshlrev_b32 v38, 16, v92
 v_and_b32 v39, s40, v92
 v_cvt_pk_bf16_f32 v92, v88, v89
 v_lshlrev_b32 v88, 16, v92
 v_and_b32 v89, s40, v92
 v_cvt_pk_bf16_f32 v92, v90, v91
 v_lshlrev_b32 v90, 16, v92
 v_and_b32 v91, s40, v92
 v_add_f32 v36, v36, v88
 v_add_f32 v37, v37, v89
 v_add_f32 v38, v38, v90
 v_add_f32 v39, v39, v91
 v_cvt_pk_bf16_f32 v98, v36, v37
 v_cvt_pk_bf16_f32 v99, v38, v39
 buffer_store_dwordx2 v[98:99], v22, s[36:39], 0 offen offset:512 sc1
 v_pk_add_f32 v[40:41], v[40:41], v[72:73]
 v_pk_add_f32 v[42:43], v[42:43], v[74:75]
 v_and_b32 v88, s40, v109
 v_lshlrev_b32 v89, 16, v109
 v_and_b32 v90, s40, v108
 v_lshlrev_b32 v91, 16, v108
 v_mul_f32 v88, s93, v88
 v_mul_f32 v89, s93, v89
 v_mul_f32 v90, s93, v90
 v_mul_f32 v91, s93, v91
 v_cvt_pk_bf16_f32 v92, v40, v41
 v_lshlrev_b32 v40, 16, v92
 v_and_b32 v41, s40, v92
 v_cvt_pk_bf16_f32 v92, v42, v43
 v_lshlrev_b32 v42, 16, v92
 v_and_b32 v43, s40, v92
 v_cvt_pk_bf16_f32 v92, v88, v89
 v_lshlrev_b32 v88, 16, v92
 v_and_b32 v89, s40, v92
 v_cvt_pk_bf16_f32 v92, v90, v91
 v_lshlrev_b32 v90, 16, v92
 v_and_b32 v91, s40, v92
 v_add_f32 v40, v40, v88
 v_add_f32 v41, v41, v89
 v_add_f32 v42, v42, v90
 v_add_f32 v43, v43, v91
 v_cvt_pk_bf16_f32 v100, v40, v41
 v_cvt_pk_bf16_f32 v101, v42, v43
 buffer_store_dwordx2 v[100:101], v22, s[36:39], 0 offen offset:1024 sc1
 v_pk_add_f32 v[44:45], v[44:45], v[76:77]
 v_pk_add_f32 v[46:47], v[46:47], v[78:79]
 v_and_b32 v88, s40, v111
 v_lshlrev_b32 v89, 16, v111
 v_and_b32 v90, s40, v110
 v_lshlrev_b32 v91, 16, v110
 v_mul_f32 v88, s93, v88
 v_mul_f32 v89, s93, v89
 v_mul_f32 v90, s93, v90
 v_mul_f32 v91, s93, v91
 v_cvt_pk_bf16_f32 v92, v44, v45
 v_lshlrev_b32 v44, 16, v92
 v_and_b32 v45, s40, v92
 v_cvt_pk_bf16_f32 v92, v46, v47
 v_lshlrev_b32 v46, 16, v92
 v_and_b32 v47, s40, v92
 v_cvt_pk_bf16_f32 v92, v88, v89
 v_lshlrev_b32 v88, 16, v92
 v_and_b32 v89, s40, v92
 v_cvt_pk_bf16_f32 v92, v90, v91
 v_lshlrev_b32 v90, 16, v92
 v_and_b32 v91, s40, v92
 v_add_f32 v44, v44, v88
 v_add_f32 v45, v45, v89
 v_add_f32 v46, v46, v90
 v_add_f32 v47, v47, v91
 v_cvt_pk_bf16_f32 v102, v44, v45
 v_cvt_pk_bf16_f32 v103, v46, v47
 buffer_store_dwordx2 v[102:103], v22, s[36:39], 0 offen offset:1536 sc1
 s_mov_b32 s92, 0
poll2:
 buffer_load_dword v30, v20, s[36:39], 0 offen sc1
 s_add_u32 s92, s92, 1
 s_cmp_ge_u32 s92, 0x40000
 s_cbranch_scc1 pollx2
 s_waitcnt vmcnt(0)
 v_cmp_ne_u32 vcc, 1, v30
 s_cbranch_vccz pollx2
 s_sleep 1
 s_branch poll2
pollx2:
 s_mov_b32 s91, 0
 buffer_load_dwordx4 a[64:67], v4, s[36:39], s91 offen offset:0 sc1
 buffer_load_dwordx4 a[68:71], v5, s[36:39], s91 offen offset:0 sc1
 buffer_load_dwordx4 a[72:75], v6, s[36:39], s91 offen offset:0 sc1
 buffer_load_dwordx4 a[76:79], v7, s[36:39], s91 offen offset:0 sc1
 buffer_load_dwordx4 a[80:83], v4, s[36:39], s91 offen offset:1024 sc1
 buffer_load_dwordx4 a[84:87], v5, s[36:39], s91 offen offset:1024 sc1
 buffer_load_dwordx4 a[88:91], v6, s[36:39], s91 offen offset:1024 sc1
 buffer_load_dwordx4 a[92:95], v7, s[36:39], s91 offen offset:1024 sc1
 buffer_load_dwordx4 a[96:99], v4, s[36:39], s91 offen offset:2048 sc1
 buffer_load_dwordx4 a[100:103], v5, s[36:39], s91 offen offset:2048 sc1
 buffer_load_dwordx4 a[104:107], v6, s[36:39], s91 offen offset:2048 sc1
 buffer_load_dwordx4 a[108:111], v7, s[36:39], s91 offen offset:2048 sc1
 buffer_load_dwordx4 a[112:115], v4, s[36:39], s91 offen offset:3072 sc1
 buffer_load_dwordx4 a[116:119], v5, s[36:39], s91 offen offset:3072 sc1
 buffer_load_dwordx4 a[120:123], v6, s[36:39], s91 offen offset:3072 sc1
 buffer_load_dwordx4 a[124:127], v7, s[36:39], s91 offen offset:3072 sc1
 v_xor_b32 v0, 0, v28
 ds_read_b64_tr_b16 v[208:209], v0 offset:16384
 ds_read_b64_tr_b16 v[210:211], v0 offset:16896
 v_xor_b32 v0, 32, v28
 ds_read_b64_tr_b16 v[212:213], v0 offset:16384
 ds_read_b64_tr_b16 v[214:215], v0 offset:16896
 v_xor_b32 v0, 64, v28
 ds_read_b64_tr_b16 v[216:217], v0 offset:16384
 ds_read_b64_tr_b16 v[218:219], v0 offset:16896
 v_xor_b32 v0, 96, v28
 ds_read_b64_tr_b16 v[220:221], v0 offset:16384
 ds_read_b64_tr_b16 v[222:223], v0 offset:16896
 v_xor_b32 v0, 0, v28
 ds_read_b64_tr_b16 v[224:225], v0 offset:32768
 ds_read_b64_tr_b16 v[226:227], v0 offset:33280
 v_xor_b32 v0, 32, v28
 ds_read_b64_tr_b16 v[228:229], v0 offset:32768
 ds_read_b64_tr_b16 v[230:231], v0 offset:33280
 v_xor_b32 v0, 64, v28
 ds_read_b64_tr_b16 v[232:233], v0 offset:32768
 ds_read_b64_tr_b16 v[234:235], v0 offset:33280
 v_xor_b32 v0, 96, v28
 ds_read_b64_tr_b16 v[236:237], v0 offset:32768
 ds_read_b64_tr_b16 v[238:239], v0 offset:33280
 v_xor_b32 v0, 0, v28
 ds_read_b64_tr_b16 v[240:241], v0 offset:49152
 ds_read_b64_tr_b16 v[242:243], v0 offset:49664
 v_xor_b32 v0, 32, v28
 ds_read_b64_tr_b16 v[244:245], v0 offset:49152
 ds_read_b64_tr_b16 v[246:247], v0 offset:49664
 v_xor_b32 v0, 64, v28
 ds_read_b64_tr_b16 v[248:249], v0 offset:49152
 ds_read_b64_tr_b16 v[250:251], v0 offset:49664
 v_xor_b32 v0, 96, v28
 ds_read_b64_tr_b16 v[252:253], v0 offset:49152
 ds_read_b64_tr_b16 v[254:255], v0 offset:49664
 v_add_u32 v30, 124160, v28
 v_xor_b32 v0, 0, v30
 ds_read_b64_tr_b16 v[48:49], v0 offset:0
 ds_read_b64_tr_b16 v[50:51], v0 offset:512
 v_xor_b32 v0, 32, v30
 ds_read_b64_tr_b16 v[52:53], v0 offset:0
 ds_read_b64_tr_b16 v[54:55], v0 offset:512
 v_xor_b32 v0, 64, v30
 ds_read_b64_tr_b16 v[56:57], v0 offset:0
 ds_read_b64_tr_b16 v[58:59], v0 offset:512
 v_xor_b32 v0, 96, v30
 ds_read_b64_tr_b16 v[60:61], v0 offset:0
 ds_read_b64_tr_b16 v[62:63], v0 offset:512
 v_add_u32 v30, 140544, v28
 v_xor_b32 v0, 0, v30
 ds_read_b64_tr_b16 v[64:65], v0 offset:0
 ds_read_b64_tr_b16 v[66:67], v0 offset:512
 v_xor_b32 v0, 32, v30
 ds_read_b64_tr_b16 v[68:69], v0 offset:0
 ds_read_b64_tr_b16 v[70:71], v0 offset:512
 v_xor_b32 v0, 64, v30
 ds_read_b64_tr_b16 v[72:73], v0 offset:0
 ds_read_b64_tr_b16 v[74:75], v0 offset:512
 v_xor_b32 v0, 96, v30
 ds_read_b64_tr_b16 v[76:77], v0 offset:0
 ds_read_b64_tr_b16 v[78:79], v0 offset:512
 s_waitcnt lgkmcnt(0)
 s_barrier
 s_cmp_lg_u32 s3, 0
 s_cbranch_scc1 sig2
 s_mov_b64 exec, 2
 buffer_store_dword v31, v11, s[36:39], 0 offen sc1
 s_mov_b64 exec, -1
sig2:
 s_waitcnt vmcnt(12)
 v_mfma_f32_16x16x32_bf16 a[0:3], a[64:67], v[112:115], 0
 s_mov_b32 s91, 4096
 buffer_load_dwordx4 a[128:131], v4, s[36:39], s91 offen offset:0 sc1
 v_mfma_f32_16x16x32_bf16 a[16:19], a[68:71], v[112:115], 0
 buffer_load_dwordx4 a[132:135], v5, s[36:39], s91 offen offset:0 sc1
 v_mfma_f32_16x16x32_bf16 a[32:35], a[72:75], v[112:115], 0
 buffer_load_dwordx4 a[136:139], v6, s[36:39], s91 offen offset:0 sc1
 v_mfma_f32_16x16x32_bf16 a[48:51], a[76:79], v[112:115], 0
 buffer_load_dwordx4 a[140:143], v7, s[36:39], s91 offen offset:0 sc1
 v_mfma_f32_16x16x32_bf16 a[4:7], a[64:67], v[116:119], 0
 v_mfma_f32_16x16x32_bf16 a[20:23], a[68:71], v[116:119], 0
 v_mfma_f32_16x16x32_bf16 a[36:39], a[72:75], v[116:119], 0
 v_mfma_f32_16x16x32_bf16 a[52:55], a[76:79], v[116:119], 0
 v_mfma_f32_16x16x32_bf16 a[8:11], a[64:67], v[120:123], 0
 v_mfma_f32_16x16x32_bf16 a[24:27], a[68:71], v[120:123], 0
 v_mfma_f32_16x16x32_bf16 a[40:43], a[72:75], v[120:123], 0
 v_mfma_f32_16x16x32_bf16 a[56:59], a[76:79], v[120:123], 0
 v_mfma_f32_16x16x32_bf16 a[12:15], a[64:67], v[124:127], 0
 v_mfma_f32_16x16x32_bf16 a[28:31], a[68:71], v[124:127], 0
 v_mfma_f32_16x16x32_bf16 a[44:47], a[72:75], v[124:127], 0
 v_mfma_f32_16x16x32_bf16 a[60:63], a[76:79], v[124:127], 0
 s_waitcnt vmcnt(12)
 v_mfma_f32_16x16x32_bf16 a[0:3], a[80:83], v[128:131], a[0:3]
 buffer_load_dwordx4 a[144:147], v4, s[36:39], s91 offen offset:1024 sc1
 v_mfma_f32_16x16x32_bf16 a[16:19], a[84:87], v[128:131], a[16:19]
 buffer_load_dwordx4 a[148:151], v5, s[36:39], s91 offen offset:1024 sc1
 v_mfma_f32_16x16x32_bf16 a[32:35], a[88:91], v[128:131], a[32:35]
 buffer_load_dwordx4 a[152:155], v6, s[36:39], s91 offen offset:1024 sc1
 v_mfma_f32_16x16x32_bf16 a[48:51], a[92:95], v[128:131], a[48:51]
 buffer_load_dwordx4 a[156:159], v7, s[36:39], s91 offen offset:1024 sc1
 v_mfma_f32_16x16x32_bf16 a[4:7], a[80:83], v[132:135], a[4:7]
 v_mfma_f32_16x16x32_bf16 a[20:23], a[84:87], v[132:135], a[20:23]
 v_mfma_f32_16x16x32_bf16 a[36:39], a[88:91], v[132:135], a[36:39]
 v_mfma_f32_16x16x32_bf16 a[52:55], a[92:95], v[132:135], a[52:55]
 v_mfma_f32_16x16x32_bf16 a[8:11], a[80:83], v[136:139], a[8:11]
 v_mfma_f32_16x16x32_bf16 a[24:27], a[84:87], v[136:139], a[24:27]
 v_mfma_f32_16x16x32_bf16 a[40:43], a[88:91], v[136:139], a[40:43]
 v_mfma_f32_16x16x32_bf16 a[56:59], a[92:95], v[136:139], a[56:59]
 v_mfma_f32_16x16x32_bf16 a[12:15], a[80:83], v[140:143], a[12:15]
 v_mfma_f32_16x16x32_bf16 a[28:31], a[84:87], v[140:143], a[28:31]
 v_mfma_f32_16x16x32_bf16 a[44:47], a[88:91], v[140:143], a[44:47]
 v_mfma_f32_16x16x32_bf16 a[60:63], a[92:95], v[140:143], a[60:63]
 s_waitcnt vmcnt(12)
 v_mfma_f32_16x16x32_bf16 a[0:3], a[96:99], v[144:147], a[0:3]
 buffer_load_dwordx4 a[160:163], v4, s[36:39], s91 offen offset:2048 sc1
 v_mfma_f32_16x16x32_bf16 a[16:19], a[100:103], v[144:147], a[16:19]
 buffer_load_dwordx4 a[164:167], v5, s[36:39], s91 offen offset:2048 sc1
 v_mfma_f32_16x16x32_bf16 a[32:35], a[104:107], v[144:147], a[32:35]
 buffer_load_dwordx4 a[168:171], v6, s[36:39], s91 offen offset:2048 sc1
 v_mfma_f32_16x16x32_bf16 a[48:51], a[108:111], v[144:147], a[48:51]
 buffer_load_dwordx4 a[172:175], v7, s[36:39], s91 offen offset:2048 sc1
 v_mfma_f32_16x16x32_bf16 a[4:7], a[96:99], v[148:151], a[4:7]
 v_mfma_f32_16x16x32_bf16 a[20:23], a[100:103], v[148:151], a[20:23]
 v_mfma_f32_16x16x32_bf16 a[36:39], a[104:107], v[148:151], a[36:39]
 v_mfma_f32_16x16x32_bf16 a[52:55], a[108:111], v[148:151], a[52:55]
 v_mfma_f32_16x16x32_bf16 a[8:11], a[96:99], v[152:155], a[8:11]
 v_mfma_f32_16x16x32_bf16 a[24:27], a[100:103], v[152:155], a[24:27]
 v_mfma_f32_16x16x32_bf16 a[40:43], a[104:107], v[152:155], a[40:43]
 v_mfma_f32_16x16x32_bf16 a[56:59], a[108:111], v[152:155], a[56:59]
 v_mfma_f32_16x16x32_bf16 a[12:15], a[96:99], v[156:159], a[12:15]
 v_mfma_f32_16x16x32_bf16 a[28:31], a[100:103], v[156:159], a[28:31]
 v_mfma_f32_16x16x32_bf16 a[44:47], a[104:107], v[156:159], a[44:47]
 v_mfma_f32_16x16x32_bf16 a[60:63], a[108:111], v[156:159], a[60:63]
 s_waitcnt vmcnt(12)
 v_mfma_f32_16x16x32_bf16 a[0:3], a[112:115], v[160:163], a[0:3]
 buffer_load_dwordx4 a[176:179], v4, s[36:39], s91 offen offset:3072 sc1
 v_mfma_f32_16x16x32_bf16 a[16:19], a[116:119], v[160:163], a[16:19]
 buffer_load_dwordx4 a[180:183], v5, s[36:39], s91 offen offset:3072 sc1
 v_mfma_f32_16x16x32_bf16 a[32:35], a[120:123], v[160:163], a[32:35]
 buffer_load_dwordx4 a[184:187], v6, s[36:39], s91 offen offset:3072 sc1
 v_mfma_f32_16x16x32_bf16 a[48:51], a[124:127], v[160:163], a[48:51]
 buffer_load_dwordx4 a[188:191], v7, s[36:39], s91 offen offset:3072 sc1
 v_mfma_f32_16x16x32_bf16 a[4:7], a[112:115], v[164:167], a[4:7]
 buffer_load_dwordx2 v[32:33], v10, s[4:7], 0 offen offset:0
 v_mfma_f32_16x16x32_bf16 a[20:23], a[116:119], v[164:167], a[20:23]
 buffer_load_dwordx2 v[34:35], v10, s[4:7], 0 offen offset:1024
 v_mfma_f32_16x16x32_bf16 a[36:39], a[120:123], v[164:167], a[36:39]
 buffer_load_dwordx2 v[36:37], v10, s[4:7], 0 offen offset:2048
 v_mfma_f32_16x16x32_bf16 a[52:55], a[124:127], v[164:167], a[52:55]
 buffer_load_dwordx2 v[38:39], v10, s[4:7], 0 offen offset:3072
 v_mfma_f32_16x16x32_bf16 a[8:11], a[112:115], v[168:171], a[8:11]
 v_mfma_f32_16x16x32_bf16 a[24:27], a[116:119], v[168:171], a[24:27]
 v_mfma_f32_16x16x32_bf16 a[40:43], a[120:123], v[168:171], a[40:43]
 v_mfma_f32_16x16x32_bf16 a[56:59], a[124:127], v[168:171], a[56:59]
 v_mfma_f32_16x16x32_bf16 a[12:15], a[112:115], v[172:175], a[12:15]
 v_mfma_f32_16x16x32_bf16 a[28:31], a[116:119], v[172:175], a[28:31]
 v_mfma_f32_16x16x32_bf16 a[44:47], a[120:123], v[172:175], a[44:47]
 v_mfma_f32_16x16x32_bf16 a[60:63], a[124:127], v[172:175], a[60:63]
 s_waitcnt vmcnt(16)
 v_mfma_f32_16x16x32_bf16 a[0:3], a[128:131], v[176:179], a[0:3]
 s_mov_b32 s91, 8192
 buffer_load_dwordx4 a[192:195], v4, s[36:39], s91 offen offset:0 sc1
 v_mfma_f32_16x16x32_bf16 a[16:19], a[132:135], v[176:179], a[16:19]
 buffer_load_dwordx4 a[196:199], v5, s[36:39], s91 offen offset:0 sc1
 v_mfma_f32_16x16x32_bf16 a[32:35], a[136:139], v[176:179], a[32:35]
 buffer_load_dwordx4 a[200:203], v6, s[36:39], s91 offen offset:0 sc1
 v_mfma_f32_16x16x32_bf16 a[48:51], a[140:143], v[176:179], a[48:51]
 buffer_load_dwordx4 a[204:207], v7, s[36:39], s91 offen offset:0 sc1
 v_mfma_f32_16x16x32_bf16 a[4:7], a[128:131], v[180:183], a[4:7]
 buffer_load_dwordx2 v[40:41], v17, s[36:39], 0 offen offset:0 sc1
 v_mfma_f32_16x16x32_bf16 a[20:23], a[132:135], v[180:183], a[20:23]
 buffer_load_dwordx2 v[42:43], v17, s[36:39], 0 offen offset:16 sc1
 v_mfma_f32_16x16x32_bf16 a[36:39], a[136:139], v[180:183], a[36:39]
 buffer_load_dwordx2 v[44:45], v17, s[36:39], 0 offen offset:32 sc1
 v_mfma_f32_16x16x32_bf16 a[52:55], a[140:143], v[180:183], a[52:55]
 buffer_load_dwordx2 v[46:47], v17, s[36:39], 0 offen offset:48 sc1
 v_mfma_f32_16x16x32_bf16 a[8:11], a[128:131], v[184:187], a[8:11]
 v_mfma_f32_16x16x32_bf16 a[24:27], a[132:135], v[184:187], a[24:27]
 v_mfma_f32_16x16x32_bf16 a[40:43], a[136:139], v[184:187], a[40:43]
 v_mfma_f32_16x16x32_bf16 a[56:59], a[140:143], v[184:187], a[56:59]
 v_mfma_f32_16x16x32_bf16 a[12:15], a[128:131], v[188:191], a[12:15]
 v_mfma_f32_16x16x32_bf16 a[28:31], a[132:135], v[188:191], a[28:31]
 v_mfma_f32_16x16x32_bf16 a[44:47], a[136:139], v[188:191], a[44:47]
 v_mfma_f32_16x16x32_bf16 a[60:63], a[140:143], v[188:191], a[60:63]
 s_waitcnt vmcnt(20)
 v_mfma_f32_16x16x32_bf16 a[0:3], a[144:147], v[192:195], a[0:3]
 buffer_load_dwordx4 a[208:211], v4, s[36:39], s91 offen offset:1024 sc1
 v_mfma_f32_16x16x32_bf16 a[16:19], a[148:151], v[192:195], a[16:19]
 buffer_load_dwordx4 a[212:215], v5, s[36:39], s91 offen offset:1024 sc1
 v_mfma_f32_16x16x32_bf16 a[32:35], a[152:155], v[192:195], a[32:35]
 buffer_load_dwordx4 a[216:219], v6, s[36:39], s91 offen offset:1024 sc1
 v_mfma_f32_16x16x32_bf16 a[48:51], a[156:159], v[192:195], a[48:51]
 buffer_load_dwordx4 a[220:223], v7, s[36:39], s91 offen offset:1024 sc1
 v_mfma_f32_16x16x32_bf16 a[4:7], a[144:147], v[196:199], a[4:7]
 buffer_load_dword v30, v21, s[36:39], 0 offen sc1
 v_mfma_f32_16x16x32_bf16 a[20:23], a[148:151], v[196:199], a[20:23]
 v_mfma_f32_16x16x32_bf16 a[36:39], a[152:155], v[196:199], a[36:39]
 v_mfma_f32_16x16x32_bf16 a[52:55], a[156:159], v[196:199], a[52:55]
 v_mfma_f32_16x16x32_bf16 a[8:11], a[144:147], v[200:203], a[8:11]
 v_mfma_f32_16x16x32_bf16 a[24:27], a[148:151], v[200:203], a[24:27]
 v_mfma_f32_16x16x32_bf16 a[40:43], a[152:155], v[200:203], a[40:43]
 v_mfma_f32_16x16x32_bf16 a[56:59], a[156:159], v[200:203], a[56:59]
 v_mfma_f32_16x16x32_bf16 a[12:15], a[144:147], v[204:207], a[12:15]
 v_mfma_f32_16x16x32_bf16 a[28:31], a[148:151], v[204:207], a[28:31]
 v_mfma_f32_16x16x32_bf16 a[44:47], a[152:155], v[204:207], a[44:47]
 v_mfma_f32_16x16x32_bf16 a[60:63], a[156:159], v[204:207], a[60:63]
 s_waitcnt vmcnt(21)
 v_mfma_f32_16x16x32_bf16 a[0:3], a[160:163], v[208:211], a[0:3]
 buffer_load_dwordx4 a[224:227], v4, s[36:39], s91 offen offset:2048 sc1
 v_mfma_f32_16x16x32_bf16 a[16:19], a[164:167], v[208:211], a[16:19]
 buffer_load_dwordx4 a[228:231], v5, s[36:39], s91 offen offset:2048 sc1
 v_mfma_f32_16x16x32_bf16 a[32:35], a[168:171], v[208:211], a[32:35]
 buffer_load_dwordx4 a[232:235], v6, s[36:39], s91 offen offset:2048 sc1
 v_mfma_f32_16x16x32_bf16 a[48:51], a[172:175], v[208:211], a[48:51]
 buffer_load_dwordx4 a[236:239], v7, s[36:39], s91 offen offset:2048 sc1
 v_mfma_f32_16x16x32_bf16 a[4:7], a[160:163], v[212:215], a[4:7]
 v_mfma_f32_16x16x32_bf16 a[20:23], a[164:167], v[212:215], a[20:23]
 v_mfma_f32_16x16x32_bf16 a[36:39], a[168:171], v[212:215], a[36:39]
 v_mfma_f32_16x16x32_bf16 a[52:55], a[172:175], v[212:215], a[52:55]
 v_mfma_f32_16x16x32_bf16 a[8:11], a[160:163], v[216:219], a[8:11]
 v_mfma_f32_16x16x32_bf16 a[24:27], a[164:167], v[216:219], a[24:27]
 v_mfma_f32_16x16x32_bf16 a[40:43], a[168:171], v[216:219], a[40:43]
 v_mfma_f32_16x16x32_bf16 a[56:59], a[172:175], v[216:219], a[56:59]
 v_mfma_f32_16x16x32_bf16 a[12:15], a[160:163], v[220:223], a[12:15]
 v_mfma_f32_16x16x32_bf16 a[28:31], a[164:167], v[220:223], a[28:31]
 v_mfma_f32_16x16x32_bf16 a[44:47], a[168:171], v[220:223], a[44:47]
 v_mfma_f32_16x16x32_bf16 a[60:63], a[172:175], v[220:223], a[60:63]
 s_waitcnt vmcnt(4)
 v_cmp_ne_u32 vcc, 1, v30
 s_cbranch_vccz z_ok
 s_mov_b32 s92, 0
poll3:
 buffer_load_dword v30, v21, s[36:39], 0 offen sc1
 s_add_u32 s92, s92, 1
 s_cmp_ge_u32 s92, 0x40000
 s_cbranch_scc1 pollx3
 s_waitcnt vmcnt(0)
 v_cmp_ne_u32 vcc, 1, v30
 s_cbranch_vccz pollx3
 s_sleep 1
 s_branch poll3
pollx3:
z_ok:
 s_waitcnt vmcnt(21)
 v_mfma_f32_16x16x32_bf16 a[0:3], a[176:179], v[224:227], a[0:3]
 buffer_load_dwordx2 v[80:81], v12, s[36:39], 0 offen sc1
 v_mfma_f32_16x16x32_bf16 a[16:19], a[180:183], v[224:227], a[16:19]
 buffer_load_dwordx2 v[82:83], v12, s[36:39], s41 offen sc1
 v_mfma_f32_16x16x32_bf16 a[32:35], a[184:187], v[224:227], a[32:35]
 buffer_load_dwordx2 v[84:85], v12, s[36:39], s98 offen sc1
 v_mfma_f32_16x16x32_bf16 a[48:51], a[188:191], v[224:227], a[48:51]
 buffer_load_dwordx2 v[86:87], v12, s[36:39], s99 offen sc1
 v_mfma_f32_16x16x32_bf16 a[4:7], a[176:179], v[228:231], a[4:7]
 v_mfma_f32_16x16x32_bf16 a[20:23], a[180:183], v[228:231], a[20:23]
 v_mfma_f32_16x16x32_bf16 a[36:39], a[184:187], v[228:231], a[36:39]
 v_mfma_f32_16x16x32_bf16 a[52:55], a[188:191], v[228:231], a[52:55]
 v_mfma_f32_16x16x32_bf16 a[8:11], a[176:179], v[232:235], a[8:11]
 v_mfma_f32_16x16x32_bf16 a[24:27], a[180:183], v[232:235], a[24:27]
 v_mfma_f32_16x16x32_bf16 a[40:43], a[184:187], v[232:235], a[40:43]
 v_mfma_f32_16x16x32_bf16 a[56:59], a[188:191], v[232:235], a[56:59]
 v_mfma_f32_16x16x32_bf16 a[12:15], a[176:179], v[236:239], a[12:15]
 v_mfma_f32_16x16x32_bf16 a[28:31], a[180:183], v[236:239], a[28:31]
 v_mfma_f32_16x16x32_bf16 a[44:47], a[184:187], v[236:239], a[44:47]
 v_mfma_f32_16x16x32_bf16 a[60:63], a[188:191], v[236:239], a[60:63]
 s_waitcnt vmcnt(17)
 v_mfma_f32_16x16x32_bf16 a[0:3], a[192:195], v[240:243], a[0:3]
 v_mfma_f32_16x16x32_bf16 a[16:19], a[196:199], v[240:243], a[16:19]
 v_mfma_f32_16x16x32_bf16 a[32:35], a[200:203], v[240:243], a[32:35]
 v_mfma_f32_16x16x32_bf16 a[48:51], a[204:207], v[240:243], a[48:51]
 v_mfma_f32_16x16x32_bf16 a[4:7], a[192:195], v[244:247], a[4:7]
 v_mfma_f32_16x16x32_bf16 a[20:23], a[196:199], v[244:247], a[20:23]
 v_mfma_f32_16x16x32_bf16 a[36:39], a[200:203], v[244:247], a[36:39]
 v_mfma_f32_16x16x32_bf16 a[52:55], a[204:207], v[244:247], a[52:55]
 v_mfma_f32_16x16x32_bf16 a[8:11], a[192:195], v[248:251], a[8:11]
 v_mfma_f32_16x16x32_bf16 a[24:27], a[196:199], v[248:251], a[24:27]
 v_mfma_f32_16x16x32_bf16 a[40:43], a[200:203], v[248:251], a[40:43]
 v_mfma_f32_16x16x32_bf16 a[56:59], a[204:207], v[248:251], a[56:59]
 v_mfma_f32_16x16x32_bf16 a[12:15], a[192:195], v[252:255], a[12:15]
 v_mfma_f32_16x16x32_bf16 a[28:31], a[196:199], v[252:255], a[28:31]
 v_mfma_f32_16x16x32_bf16 a[44:47], a[200:203], v[252:255], a[44:47]
 v_mfma_f32_16x16x32_bf16 a[60:63], a[204:207], v[252:255], a[60:63]
 s_waitcnt vmcnt(9)
 v_mfma_f32_16x16x32_bf16 a[0:3], a[208:211], v[48:51], a[0:3]
 v_lshlrev_b32 v128, 16, v32
 v_and_b32 v129, s40, v32
 v_mfma_f32_16x16x32_bf16 a[16:19], a[212:215], v[48:51], a[16:19]
 v_lshlrev_b32 v144, 16, v40
 v_and_b32 v145, s40, v40
 v_mfma_f32_16x16x32_bf16 a[32:35], a[216:219], v[48:51], a[32:35]
 v_lshlrev_b32 v130, 16, v33
 v_and_b32 v131, s40, v33
 v_mfma_f32_16x16x32_bf16 a[48:51], a[220:223], v[48:51], a[48:51]
 v_lshlrev_b32 v146, 16, v41
 v_and_b32 v147, s40, v41
 v_mfma_f32_16x16x32_bf16 a[4:7], a[208:211], v[52:55], a[4:7]
 v_lshlrev_b32 v132, 16, v34
 v_and_b32 v133, s40, v34
 v_mfma_f32_16x16x32_bf16 a[20:23], a[212:215], v[52:55], a[20:23]
 v_lshlrev_b32 v148, 16, v42
 v_and_b32 v149, s40, v42
 v_mfma_f32_16x16x32_bf16 a[36:39], a[216:219], v[52:55], a[36:39]
 v_lshlrev_b32 v134, 16, v35
 v_and_b32 v135, s40, v35
 v_mfma_f32_16x16x32_bf16 a[52:55], a[220:223], v[52:55], a[52:55]
 v_lshlrev_b32 v150, 16, v43
 v_and_b32 v151, s40, v43
 v_mfma_f32_16x16x32_bf16 a[8:11], a[208:211], v[56:59], a[8:11]
 v_lshlrev_b32 v136, 16, v36
 v_and_b32 v137, s40, v36
 v_mfma_f32_16x16x32_bf16 a[24:27], a[212:215], v[56:59], a[24:27]
 v_lshlrev_b32 v152, 16, v44
 v_and_b32 v153, s40, v44
 v_mfma_f32_16x16x32_bf16 a[40:43], a[216:219], v[56:59], a[40:43]
 v_lshlrev_b32 v138, 16, v37
 v_and_b32 v139, s40, v37
 v_mfma_f32_16x16x32_bf16 a[56:59], a[220:223], v[56:59], a[56:59]
 v_lshlrev_b32 v154, 16, v45
 v_and_b32 v155, s40, v45
 v_mfma_f32_16x16x32_bf16 a[12:15], a[208:211], v[60:63], a[12:15]
 v_lshlrev_b32 v140, 16, v38
 v_and_b32 v141, s40, v38
 v_mfma_f32_16x16x32_bf16 a[28:31], a[212:215], v[60:63], a[28:31]
 v_lshlrev_b32 v156, 16, v46
 v_and_b32 v157, s40, v46
 v_mfma_f32_16x16x32_bf16 a[44:47], a[216:219], v[60:63], a[44:47]
 v_lshlrev_b32 v142, 16, v39
 v_and_b32 v143, s40, v39
 v_mfma_f32_16x16x32_bf16 a[60:63], a[220:223], v[60:63], a[60:63]
 v_lshlrev_b32 v158, 16, v47
 v_and_b32 v159, s40, v47
 s_waitcnt vmcnt(4)
 s_cmp_eq_u32 s3, 3
 s_cbranch_scc1 k3_skip
 v_mfma_f32_16x16x32_bf16 a[0:3], a[224:227], v[64:67], a[0:3]
 v_mfma_f32_16x16x32_bf16 a[16:19], a[228:231], v[64:67], a[16:19]
 v_mfma_f32_16x16x32_bf16 a[32:35], a[232:235], v[64:67], a[32:35]
 v_mfma_f32_16x16x32_bf16 a[48:51], a[236:239], v[64:67], a[48:51]
 v_mfma_f32_16x16x32_bf16 a[4:7], a[224:227], v[68:71], a[4:7]
 v_mfma_f32_16x16x32_bf16 a[20:23], a[228:231], v[68:71], a[20:23]
 v_mfma_f32_16x16x32_bf16 a[36:39], a[232:235], v[68:71], a[36:39]
 v_mfma_f32_16x16x32_bf16 a[52:55], a[236:239], v[68:71], a[52:55]
 v_mfma_f32_16x16x32_bf16 a[8:11], a[224:227], v[72:75], a[8:11]
 v_mfma_f32_16x16x32_bf16 a[24:27], a[228:231], v[72:75], a[24:27]
 v_mfma_f32_16x16x32_bf16 a[40:43], a[232:235], v[72:75], a[40:43]
 v_mfma_f32_16x16x32_bf16 a[56:59], a[236:239], v[72:75], a[56:59]
 v_mfma_f32_16x16x32_bf16 a[12:15], a[224:227], v[76:79], a[12:15]
 v_mfma_f32_16x16x32_bf16 a[28:31], a[228:231], v[76:79], a[28:31]
 v_mfma_f32_16x16x32_bf16 a[44:47], a[232:235], v[76:79], a[44:47]
 v_mfma_f32_16x16x32_bf16 a[60:63], a[236:239], v[76:79], a[60:63]
k3_skip:
 s_nop 7
 s_nop 3
 ds_write_b128 v15, a[0:3] offset:0
 ds_write_b128 v15, a[16:19] offset:4160
 ds_write_b128 v15, a[32:35] offset:8320
 ds_write_b128 v15, a[48:51] offset:12480
 ds_write_b128 v15, a[4:7] offset:1040
 ds_write_b128 v15, a[20:23] offset:5200
 ds_write_b128 v15, a[36:39] offset:9360
 ds_write_b128 v15, a[52:55] offset:13520
 ds_write_b128 v15, a[8:11] offset:2080
 ds_write_b128 v15, a[24:27] offset:6240
 ds_write_b128 v15, a[40:43] offset:10400
 ds_write_b128 v15, a[56:59] offset:14560
 ds_write_b128 v15, a[12:15] offset:3120
 ds_write_b128 v15, a[28:31] offset:7280
 ds_write_b128 v15, a[44:47] offset:11440
 ds_write_b128 v15, a[60:63] offset:15600
k3_join:
 s_waitcnt vmcnt(0)
 v_lshlrev_b32 v160, 16, v80
 v_and_b32 v164, s40, v80
 v_lshlrev_b32 v168, 16, v81
 v_and_b32 v172, s40, v81
 v_lshlrev_b32 v161, 16, v82
 v_and_b32 v165, s40, v82
 v_lshlrev_b32 v169, 16, v83
 v_and_b32 v173, s40, v83
 v_lshlrev_b32 v162, 16, v84
 v_and_b32 v166, s40, v84
 v_lshlrev_b32 v170, 16, v85
 v_and_b32 v174, s40, v85
 v_lshlrev_b32 v163, 16, v86
 v_and_b32 v167, s40, v86
 v_lshlrev_b32 v171, 16, v87
 v_and_b32 v175, s40, v87
 v_pk_mul_f32 v[144:145], v[144:145], v[160:161]
 v_cvt_pk_bf16_f32 v18, v144, v145
 v_lshlrev_b32 v144, 16, v18
 v_and_b32 v145, s40, v18
 v_pk_add_f32 v[128:129], v[128:129], v[144:145]
 v_cvt_pk_bf16_f32 v18, v128, v129
 v_lshlrev_b32 v128, 16, v18
 v_and_b32 v129, s40, v18
 v_pk_mul_f32 v[146:147], v[146:147], v[162:163]
 v_cvt_pk_bf16_f32 v18, v146, v147
 v_lshlrev_b32 v146, 16, v18
 v_and_b32 v147, s40, v18
 v_pk_add_f32 v[130:131], v[130:131], v[146:147]
 v_cvt_pk_bf16_f32 v18, v130, v131
 v_lshlrev_b32 v130, 16, v18
 v_and_b32 v131, s40, v18
 v_pk_mul_f32 v[148:149], v[148:149], v[164:165]
 v_cvt_pk_bf16_f32 v18, v148, v149
 v_lshlrev_b32 v148, 16, v18
 v_and_b32 v149, s40, v18
 v_pk_add_f32 v[132:133], v[132:133], v[148:149]
 v_cvt_pk_bf16_f32 v18, v132, v133
 v_lshlrev_b32 v132, 16, v18
 v_and_b32 v133, s40, v18
 v_pk_mul_f32 v[150:151], v[150:151], v[166:167]
 v_cvt_pk_bf16_f32 v18, v150, v151
 v_lshlrev_b32 v150, 16, v18
 v_and_b32 v151, s40, v18
 v_pk_add_f32 v[134:135], v[134:135], v[150:151]
 v_cvt_pk_bf16_f32 v18, v134, v135
 v_lshlrev_b32 v134, 16, v18
 v_and_b32 v135, s40, v18
 v_pk_mul_f32 v[152:153], v[152:153], v[168:169]
 v_cvt_pk_bf16_f32 v18, v152, v153
 v_lshlrev_b32 v152, 16, v18
 v_and_b32 v153, s40, v18
 v_pk_add_f32 v[136:137], v[136:137], v[152:153]
 v_cvt_pk_bf16_f32 v18, v136, v137
 v_lshlrev_b32 v136, 16, v18
 v_and_b32 v137, s40, v18
 v_pk_mul_f32 v[154:155], v[154:155], v[170:171]
 v_cvt_pk_bf16_f32 v18, v154, v155
 v_lshlrev_b32 v154, 16, v18
 v_and_b32 v155, s40, v18
 v_pk_add_f32 v[138:139], v[138:139], v[154:155]
 v_cvt_pk_bf16_f32 v18, v138, v139
 v_lshlrev_b32 v138, 16, v18
 v_and_b32 v139, s40, v18
 v_pk_mul_f32 v[156:157], v[156:157], v[172:173]
 v_cvt_pk_bf16_f32 v18, v156, v157
 v_lshlrev_b32 v156, 16, v18
 v_and_b32 v157, s40, v18
 v_pk_add_f32 v[140:141], v[140:141], v[156:157]
 v_cvt_pk_bf16_f32 v18, v140, v141
 v_lshlrev_b32 v140, 16, v18
 v_and_b32 v141, s40, v18
 v_pk_mul_f32 v[158:159], v[158:159], v[174:175]
 v_cvt_pk_bf16_f32 v18, v158, v159
 v_lshlrev_b32 v158, 16, v18
 v_and_b32 v159, s40, v18
 v_pk_add_f32 v[142:143], v[142:143], v[158:159]
 v_cvt_pk_bf16_f32 v18, v142, v143
 v_lshlrev_b32 v142, 16, v18
 v_and_b32 v143, s40, v18
 s_waitcnt lgkmcnt(0)
 s_barrier
 ds_read_b128 v[176:179], v16 offset:0
 ds_read_b128 v[180:183], v16 offset:16
 ds_read_b128 v[184:187], v16 offset:32
 ds_read_b128 v[188:191], v16 offset:48
 ds_read_b128 v[192:195], v16 offset:16640
 ds_read_b128 v[196:199], v16 offset:16656
 ds_read_b128 v[200:203], v16 offset:16672
 ds_read_b128 v[204:207], v16 offset:16688
 ds_read_b128 v[208:211], v16 offset:33280
 ds_read_b128 v[212:215], v16 offset:33296
 ds_read_b128 v[216:219], v16 offset:33312
 ds_read_b128 v[220:223], v16 offset:33328
 ds_read_b128 v[224:227], v16 offset:49920
 ds_read_b128 v[228:231], v16 offset:49936
 ds_read_b128 v[232:235], v16 offset:49952
 ds_read_b128 v[236:239], v16 offset:49968
 s_waitcnt lgkmcnt(8)
 v_pk_add_f32 v[176:177], v[176:177], v[192:193]
 v_pk_add_f32 v[178:179], v[178:179], v[194:195]
 v_pk_add_f32 v[180:181], v[180:181], v[196:197]
 v_pk_add_f32 v[182:183], v[182:183], v[198:199]
 v_pk_add_f32 v[184:185], v[184:185], v[200:201]
 v_pk_add_f32 v[186:187], v[186:187], v[202:203]
 v_pk_add_f32 v[188:189], v[188:189], v[204:205]
 v_pk_add_f32 v[190:191], v[190:191], v[206:207]
 s_waitcnt lgkmcnt(4)
 v_pk_add_f32 v[176:177], v[176:177], v[208:209]
 v_pk_add_f32 v[178:179], v[178:179], v[210:211]
 v_pk_add_f32 v[180:181], v[180:181], v[212:213]
 v_pk_add_f32 v[182:183], v[182:183], v[214:215]
 v_pk_add_f32 v[184:185], v[184:185], v[216:217]
 v_pk_add_f32 v[186:187], v[186:187], v[218:219]
 v_pk_add_f32 v[188:189], v[188:189], v[220:221]
 v_pk_add_f32 v[190:191], v[190:191], v[222:223]
 s_waitcnt lgkmcnt(0)
 v_pk_add_f32 v[176:177], v[176:177], v[224:225]
 v_pk_add_f32 v[178:179], v[178:179], v[226:227]
 v_pk_add_f32 v[180:181], v[180:181], v[228:229]
 v_pk_add_f32 v[182:183], v[182:183], v[230:231]
 v_pk_add_f32 v[184:185], v[184:185], v[232:233]
 v_pk_add_f32 v[186:187], v[186:187], v[234:235]
 v_pk_add_f32 v[188:189], v[188:189], v[236:237]
 v_pk_add_f32 v[190:191], v[190:191], v[238:239]
 v_cvt_pk_bf16_f32 v18, v176, v177
 v_lshlrev_b32 v176, 16, v18
 v_and_b32 v177, s40, v18
 v_cvt_pk_bf16_f32 v18, v178, v179
 v_lshlrev_b32 v178, 16, v18
 v_and_b32 v179, s40, v18
 v_cvt_pk_bf16_f32 v18, v180, v181
 v_lshlrev_b32 v180, 16, v18
 v_and_b32 v181, s40, v18
 v_cvt_pk_bf16_f32 v18, v182, v183
 v_lshlrev_b32 v182, 16, v18
 v_and_b32 v183, s40, v18
 v_cvt_pk_bf16_f32 v18, v184, v185
 v_lshlrev_b32 v184, 16, v18
 v_and_b32 v185, s40, v18
 v_cvt_pk_bf16_f32 v18, v186, v187
 v_lshlrev_b32 v186, 16, v18
 v_and_b32 v187, s40, v18
 v_cvt_pk_bf16_f32 v18, v188, v189
 v_lshlrev_b32 v188, 16, v18
 v_and_b32 v189, s40, v18
 v_cvt_pk_bf16_f32 v18, v190, v191
 v_lshlrev_b32 v190, 16, v18
 v_and_b32 v191, s40, v18
 v_add_f32 v128, v128, v176
 v_add_f32 v129, v129, v180
 v_add_f32 v130, v130, v184
 v_add_f32 v131, v131, v188
 v_cvt_pk_bf16_f32 v32, v128, v129
 v_cvt_pk_bf16_f32 v33, v130, v131
 buffer_store_dwordx2 v[32:33], v10, s[32:35], 0 offen offset:0
 v_add_f32 v132, v132, v177
 v_add_f32 v133, v133, v181
 v_add_f32 v134, v134, v185
 v_add_f32 v135, v135, v189
 v_cvt_pk_bf16_f32 v34, v132, v133
 v_cvt_pk_bf16_f32 v35, v134, v135
 buffer_store_dwordx2 v[34:35], v10, s[32:35], 0 offen offset:1024
 v_add_f32 v136, v136, v178
 v_add_f32 v137, v137, v182
 v_add_f32 v138, v138, v186
 v_add_f32 v139, v139, v190
 v_cvt_pk_bf16_f32 v36, v136, v137
 v_cvt_pk_bf16_f32 v37, v138, v139
 buffer_store_dwordx2 v[36:37], v10, s[32:35], 0 offen offset:2048
 v_add_f32 v140, v140, v179
 v_add_f32 v141, v141, v183
 v_add_f32 v142, v142, v187
 v_add_f32 v143, v143, v191
 v_cvt_pk_bf16_f32 v38, v140, v141
 v_cvt_pk_bf16_f32 v39, v142, v143
 buffer_store_dwordx2 v[38:39], v10, s[32:35], 0 offen offset:3072
k_end:
 s_endpgm
.section .rodata,"a"
.p2align 6
.amdhsa_kernel parallel_sum__ssm_conv_h3__dense_activation_relu__prompt_kernel
  .amdhsa_next_free_vgpr 512
  .amdhsa_next_free_sgpr 102
  .amdhsa_accum_offset 256
  .amdhsa_group_segment_fixed_size 0
  .amdhsa_kernarg_size 96
  .amdhsa_user_sgpr_count 2
  .amdhsa_user_sgpr_kernarg_segment_ptr 1
  .amdhsa_system_sgpr_workgroup_id_x 1
.end_amdhsa_kernel
```
